```python
import torch

def _softmax(x, axis=-1):
    return torch.softmax(x, dim=axis)
def _gelu(x):
    return torch.nn.functional.gelu(x, approximate="tanh")
def _silu(x):
    return torch.nn.functional.silu(x)
def _sigmoid(x):
    return torch.sigmoid(x)
def _layernorm(x, axis=-1, eps=1e-5):
    m = x.mean(dim=axis, keepdim=True)
    v = x.var(dim=axis, keepdim=True, unbiased=False)
    return (x - m) / torch.sqrt(v + eps)
def _scatter_add(tgt, idx, src, axis=0):
    return tgt.clone().index_add_(axis, idx, src)
def _segment_sum(src, seg, n):
    out = torch.zeros((n,) + src.shape[1:], dtype=src.dtype)
    return out.index_add_(0, seg, src)
def _pad(x, pw):
    flat = tuple(v for pair in reversed(pw) for v in pair)
    return torch.nn.functional.pad(x, flat)

kernel_name = 'standalone__dcn_v2_cross__recsys'

def setup_inputs():

    _w = (lambda a: (lambda t: t.to(torch.bfloat16) if t.is_floating_point() else t)(torch.as_tensor(a)))
    B, F, D, L = 1024, 100, 64, 3
    Din = min(F * D, 1024)
    return {
        "x0": _w((lambda *s: torch.randn(*s, dtype=torch.bfloat16) * 0.05)(B, Din)),
        "ws": _w((lambda *s: torch.randn(*s, dtype=torch.bfloat16) * 0.05)(L, Din, Din)),
        "bs": _w((lambda *s: torch.randn(*s, dtype=torch.bfloat16) * 0.05)(L, Din)),
    }

def reference(x0, ws, bs):
    x = x0
    for l in range(ws.shape[0]):
        x = x0 * (x @ ws[l] + bs[l]) + x
    return x
```

```asm
; @launch grid=(256,1,1) block=(256,1,1) lds=163840
.amdgcn_target "amdgcn-amd-amdhsa--gfx950"
.text
.globl standalone__dcn_v2_cross__recsys_kernel
.p2align 8
.type standalone__dcn_v2_cross__recsys_kernel,@function
standalone__dcn_v2_cross__recsys_kernel:
    s_cmp_ge_u32 s2, 256
    s_cbranch_scc1 L_end
    s_load_dwordx2 s[12:13], s[0:1], 8
    s_load_dwordx2 s[8:9], s[0:1], 0
    s_load_dwordx2 s[48:49], s[0:1], 16
    s_load_dwordx2 s[44:45], s[0:1], 32
    s_load_dwordx2 s[24:25], s[0:1], 40
    s_load_dwordx2 s[28:29], s[0:1], 24
    s_getpc_b64 s[38:39]
    s_lshr_b32 s20, s2, 3
    v_lshl_add_u32 v60, v0, 5, s20
    v_lshlrev_b32 v60, 7, v60
    v_cmp_gt_u32 vcc, L_code_end-L_nopf-128, v60
    s_and_saveexec_b64 s[36:37], vcc
    s_cbranch_execz L_nopf
    global_load_dword v61, v60, s[38:39]
L_nopf:
    s_mov_b64 exec, -1
    v_lshrrev_b32 v1, 6, v0
    v_bfe_u32 v3, v0, 3, 3
    s_bfe_u32 s16, s2, 0x20001
    v_readfirstlane_b32 s3, v1
    s_bfe_u32 s17, s2, 0x20003
    s_and_b32 s34, s2, 1
    s_bfe_u32 s35, s2, 0x10006
    v_and_b32 v4, 7, v0
    v_and_b32 v6, 2, v3
    s_add_u32 s98, s16, s17
    s_lshl1_add_u32 s98, s98, s35
    s_add_u32 s98, s98, s34
    s_bfe_u32 s19, s2, 0x30003
    v_xor_b32 v6, v4, v6
    s_lshl3_add_u32 s19, s34, s19
    v_lshlrev_b32 v6, 4, v6
    s_and_b32 s5, s98, 7
    v_lshl_add_u32 v12, v3, 11, v6
    s_lshl_b32 s20, s3, 15
    s_lshl_b32 s33, s19, 7
    v_xor_b32 v7, 64, v12
    s_add_u32 s22, s20, s33
    s_lshl_b32 s4, s5, 18
    v_add_u32 v13, 15360, v7
    s_add_u32 s4, s4, s22
    s_lshl_b32 s23, s3, 13
    v_add_u32 v14, 129024, v12
    s_mov_b32 m0, s23
    s_mov_b32 s14, 0x600000
    v_add_u32 v15, 144384, v7
    s_mov_b32 s15, 0x20000
    v_bfe_u32 v5, v0, 4, 2
    v_and_b32 v6, 15, v0
    s_lshr_b32 s18, s2, 6
    v_xor_b32 v6, v6, v5
    s_lshl2_add_u32 s18, s16, s18
    v_lshlrev_b32 v6, 4, v6
    s_lshl_b32 s21, s18, 17
    v_lshl_add_u32 v20, v5, 11, v6
    s_add_u32 s21, s21, s20
    v_xor_b32 v7, 64, v20
    s_lshl_b32 s5, s5, 8
    v_add_u32 v21, 7168, v7
    s_add_u32 s5, s5, s21
    v_xor_b32 v7, 128, v20
    v_add_u32 v22, 14336, v7
    s_mov_b32 s10, 0x200000
    v_xor_b32 v7, 192, v20
    s_mov_b32 s11, 0x20000
    v_add_u32 v23, 21504, v7
    s_lshl1_add_u32 s99, s16, s17
    s_add_u32 s99, s99, s35
    s_lshl1_add_u32 s100, s16, s17
    s_add_u32 s100, s100, s35
    v_and_b32 v2, 63, v0
    s_lshl_b32 s37, s34, 10
    s_lshr_b32 s20, s2, 3
    s_lshl_b32 s20, s20, 16
    s_add_u32 s37, s37, s20
    v_lshlrev_b32 v66, 11, v2
    v_and_b32 v6, 31, v2
    v_lshrrev_b32 v7, 5, v2
    v_lshlrev_b32 v6, 2, v6
    v_lshl_add_u32 v62, v7, 11, v6
    s_add_u32 s34, s33, 3840
    s_mov_b32 s50, 0x1800
    s_mov_b32 s51, 0x20000
    s_waitcnt lgkmcnt(0)
    buffer_load_dwordx4 v12, s[12:15], s4 offen offset:0 lds
    buffer_load_dwordx4 v13, s[12:15], s4 offen offset:1024 lds
    buffer_load_dwordx4 v14, s[12:15], s4 offen offset:2048 lds
    buffer_load_dwordx4 v15, s[12:15], s4 offen offset:3072 lds
    s_add_u32 m0, s23, 4096
    s_nop 0
    buffer_load_dwordx4 v20, s[8:11], s5 offen offset:0 lds
    buffer_load_dwordx4 v21, s[8:11], s5 offen offset:1024 lds
    buffer_load_dwordx4 v22, s[8:11], s5 offen offset:2048 lds
    buffer_load_dwordx4 v23, s[8:11], s5 offen offset:3072 lds
    s_mov_b32 m0, 139264
    s_mov_b32 s46, 256
    buffer_load_dword v62, s[48:51], s33 offen lds
    buffer_load_dword v62, s[48:51], s34 offen offset:256 lds
    s_cmp_lg_u32 s3, 3
    s_cbranch_scc1 L_help_1
    s_add_u32 s20, s37, 384
    s_mov_b64 exec, 0xffffffff
    buffer_load_dword v67, v66, s[12:15], s20 offen
    s_mov_b64 exec, -1
L_help_1:
    s_mov_b32 s47, 0x20000
    v_mov_b32 v54, 0
    s_or_b32 s20, s2, s3
    s_cmp_lg_u32 s20, 0
    s_cbranch_scc1 L_nonz
    s_memrealtime s[56:57]
    s_waitcnt lgkmcnt(0)
    s_bitset1_b32 s57, 31
    v_mov_b32 v56, s56
    v_mov_b32 v57, s57
    s_mov_b64 exec, 1
    buffer_store_dwordx2 v[56:57], v54, s[44:47], 0 offen sc1
    s_mov_b64 exec, -1
L_nonz:
    s_add_u32 s4, s98, 1
    s_and_b32 s4, s4, 7
    s_lshl_b32 s4, s4, 18
    s_add_u32 s4, s4, s22
    s_add_u32 m0, s23, 32768
    s_nop 0
    buffer_load_dwordx4 v12, s[12:15], s4 offen offset:0 lds
    buffer_load_dwordx4 v13, s[12:15], s4 offen offset:1024 lds
    buffer_load_dwordx4 v14, s[12:15], s4 offen offset:2048 lds
    buffer_load_dwordx4 v15, s[12:15], s4 offen offset:3072 lds
    s_add_u32 s5, s98, 1
    s_and_b32 s5, s5, 7
    s_lshl_b32 s5, s5, 8
    s_add_u32 s5, s5, s21
    s_add_u32 m0, s23, 36864
    s_nop 0
    buffer_load_dwordx4 v20, s[8:11], s5 offen offset:0 lds
    buffer_load_dwordx4 v21, s[8:11], s5 offen offset:1024 lds
    buffer_load_dwordx4 v22, s[8:11], s5 offen offset:2048 lds
    buffer_load_dwordx4 v23, s[8:11], s5 offen offset:3072 lds
    v_xor_b32 v6, v4, v5
    v_lshlrev_b32 v6, 4, v6
    v_lshl_add_u32 v10, v3, 11, v6
    v_xor_b32 v11, 64, v10
    v_lshlrev_b32 v6, 1, v5
    v_xor_b32 v6, v4, v6
    v_lshlrev_b32 v6, 4, v6
    v_lshl_add_u32 v16, v3, 11, v6
    v_add_u32 v17, 15360, v16
    v_add_u32 v18, 129024, v16
    v_add_u32 v19, 144384, v16
    v_lshlrev_b32 v52, 4, v2
    s_add_u32 s42, s21, s33
    s_lshl_b32 s43, s3, 11
    s_add_u32 s43, s43, 131072
    s_lshl2_add_u32 s41, s18, s3
    s_lshl_b32 s59, s41, 15
    s_lshl_b32 s58, s19, 11
    s_add_u32 s58, s58, s59
    s_lshl_b32 s57, s41, 11
    s_add_u32 s57, s57, 4194304
    s_add_u32 s56, s57, s33
    s_mov_b32 s26, 0x800000
    s_mov_b32 s27, 0x20000
    s_mov_b32 s30, 0x200000
    s_mov_b32 s31, 0x20000
    v_and_b32 v3, 15, v2
    v_lshrrev_b32 v4, 4, v2
    v_bfe_u32 v5, v2, 1, 3
    v_lshrrev_b32 v9, 1, v4
    v_xor_b32 v6, v9, v5
    v_lshlrev_b32 v6, 4, v6
    v_and_b32 v7, 1, v4
    v_lshl_add_u32 v6, v7, 3, v6
    v_lshl_add_u32 v6, v3, 7, v6
    v_add_u32 v48, s43, v6
    v_xor_b32 v49, 32, v48
    v_xor_b32 v50, 64, v48
    v_xor_b32 v51, 96, v48
    v_xor_b32 v6, v4, v3
    v_lshlrev_b32 v6, 4, v6
    v_lshl_add_u32 v6, v3, 8, v6
    s_add_u32 s20, s23, 4096
    v_add_u32 v24, s20, v6
    v_xor_b32 v25, 64, v24
    v_xor_b32 v26, 128, v24
    v_xor_b32 v27, 192, v24
    s_and_b32 s35, s19, 1
    s_lshl_b32 s35, s35, 3
    v_or_b32 v6, s35, v9
    v_xor_b32 v6, v6, v3
    v_lshlrev_b32 v6, 4, v6
    v_lshl_add_u32 v6, v7, 3, v6
    v_lshl_add_u32 v6, v3, 8, v6
    v_add_u32 v55, s20, v6
    s_lshr_b32 s36, s19, 1
    s_sub_u32 s36, s36, s98
    s_and_b32 s36, s36, 7
    v_bfe_u32 v5, v2, 2, 2
    v_and_b32 v8, 3, v2
    v_lshlrev_b32 v8, 3, v8
    v_lshrrev_b32 v6, 1, v5
    v_lshl_add_u32 v6, v7, 1, v6
    v_lshl_add_u32 v6, v6, 5, v8
    v_lshl_add_u32 v6, v5, 7, v6
    v_lshl_add_u32 v6, v7, 10, v6
    v_lshl_add_u32 v32, v9, 13, v6
    v_xor_b32 v33, 32, v32
    v_xor_b32 v34, 64, v32
    v_xor_b32 v35, 96, v32
    v_lshl_add_u32 v6, v4, 2, v5
    v_bfe_u32 v7, v6, 1, 2
    v_lshl_add_u32 v7, v7, 5, v8
    v_lshl_add_u32 v40, v6, 7, v7
    v_xor_b32 v41, 32, v40
    v_xor_b32 v42, 64, v40
    v_xor_b32 v43, 96, v40
    v_add_u32 v28, 0x10000, v24
    v_add_u32 v29, 0x10000, v25
    v_add_u32 v30, 0x10000, v26
    v_add_u32 v31, 0x10000, v27
    v_add_u32 v36, 0x10000, v32
    v_add_u32 v37, 0x10000, v33
    v_add_u32 v38, 0x10000, v34
    v_add_u32 v39, 0x10000, v35
    v_add_u32 v44, 0x10000, v40
    v_add_u32 v45, 0x10000, v41
    v_add_u32 v46, 0x10000, v42
    v_add_u32 v47, 0x10000, v43
    v_lshlrev_b32 v5, 3, v4
    v_add_u32 v63, 139264, v5
    v_lshlrev_b32 v53, 7, v3
    s_add_u32 s4, s98, 2
    s_and_b32 s4, s4, 7
    s_lshl_b32 s4, s4, 18
    s_add_u32 s4, s4, s22
    s_add_u32 m0, s23, 65536
    s_waitcnt vmcnt(8) lgkmcnt(0)
    s_barrier
    buffer_load_dwordx4 v12, s[12:15], s4 offen offset:0 lds
    s_cmp_lg_u32 s36, 0
    s_cbranch_scc1 L_xt_2
    v_add_u32 v212, 0, v55
    v_xor_b32 v213, 32, v212
    v_xor_b32 v214, 64, v212
    v_xor_b32 v215, 96, v212
    ds_read_b64 v[172:173], v212
    ds_read_b64 v[174:175], v213
    ds_read_b64 v[176:177], v214
    ds_read_b64 v[178:179], v215
L_xt_2:
    ds_read_b64 v[180:181], v63 offset:0
    ds_read_b64 v[182:183], v63 offset:32
    ds_read_b64 v[184:185], v63 offset:64
    ds_read_b64 v[186:187], v63 offset:96
    buffer_load_dwordx4 v13, s[12:15], s4 offen offset:1024 lds
    ds_read_b128 a[0:3], v24 offset:0
    ds_read_b64_tr_b16 a[4:5], v32 offset:0
    ds_read_b64_tr_b16 a[6:7], v32 offset:512
    ds_read_b64_tr_b16 a[8:9], v33 offset:0
    ds_read_b64_tr_b16 a[10:11], v33 offset:512
    ds_read_b64_tr_b16 a[12:13], v34 offset:0
    buffer_load_dwordx4 v14, s[12:15], s4 offen offset:2048 lds
    buffer_load_dwordx4 v15, s[12:15], s4 offen offset:3072 lds
    s_add_u32 s5, s98, 2
    s_and_b32 s5, s5, 7
    s_lshl_b32 s5, s5, 8
    s_add_u32 s5, s5, s21
    s_add_u32 m0, s23, 69632
    ds_read_b64_tr_b16 a[14:15], v34 offset:512
    ds_read_b64_tr_b16 a[16:17], v35 offset:0
    ds_read_b64_tr_b16 a[18:19], v35 offset:512
    ds_read_b128 a[20:23], v25 offset:0
    ds_read_b64_tr_b16 a[24:25], v32 offset:16384
    ds_read_b64_tr_b16 a[26:27], v32 offset:16896
    s_waitcnt lgkmcnt(12)
    v_lshlrev_b32 v116, 16, v180
    v_and_b32 v117, 0xffff0000, v180
    v_lshlrev_b32 v118, 16, v181
    v_and_b32 v119, 0xffff0000, v181
    v_lshlrev_b32 v120, 16, v182
    v_and_b32 v121, 0xffff0000, v182
    v_lshlrev_b32 v122, 16, v183
    v_and_b32 v123, 0xffff0000, v183
    v_lshlrev_b32 v124, 16, v184
    v_and_b32 v125, 0xffff0000, v184
    v_lshlrev_b32 v126, 16, v185
    v_and_b32 v127, 0xffff0000, v185
    v_lshlrev_b32 v128, 16, v186
    v_and_b32 v129, 0xffff0000, v186
    v_lshlrev_b32 v130, 16, v187
    v_and_b32 v131, 0xffff0000, v187
    buffer_load_dwordx4 v20, s[8:11], s5 offen offset:0 lds
    buffer_load_dwordx4 v21, s[8:11], s5 offen offset:1024 lds
    ds_read_b64_tr_b16 a[28:29], v33 offset:16384
    ds_read_b64_tr_b16 a[30:31], v33 offset:16896
    ds_read_b64_tr_b16 a[32:33], v34 offset:16384
    ds_read_b64_tr_b16 a[34:35], v34 offset:16896
    ds_read_b64_tr_b16 a[36:37], v35 offset:16384
    ds_read_b64_tr_b16 a[38:39], v35 offset:16896
    buffer_load_dwordx4 v22, s[8:11], s5 offen offset:2048 lds
    buffer_load_dwordx4 v23, s[8:11], s5 offen offset:3072 lds
    s_add_u32 s4, s98, 3
    s_and_b32 s4, s4, 7
    s_lshl_b32 s4, s4, 18
    s_add_u32 s4, s4, s22
    s_add_u32 m0, s23, 98304
    ds_read_b128 a[40:43], v26 offset:0
    ds_read_b64_tr_b16 a[44:45], v32 offset:2048
    ds_read_b64_tr_b16 a[46:47], v32 offset:2560
    ds_read_b64_tr_b16 a[48:49], v33 offset:2048
    ds_read_b64_tr_b16 a[50:51], v33 offset:2560
    buffer_load_dwordx4 v12, s[12:15], s4 offen offset:0 lds
    buffer_load_dwordx4 v13, s[12:15], s4 offen offset:1024 lds
    s_waitcnt lgkmcnt(14)
    v_mfma_f32_16x16x32_bf16 v[68:71], a[4:7], a[0:3], v[116:119]
    ds_read_b64_tr_b16 a[52:53], v34 offset:2048
    ds_read_b64_tr_b16 a[54:55], v34 offset:2560
    v_mfma_f32_16x16x32_bf16 v[72:75], a[8:11], a[0:3], v[120:123]
    ds_read_b64_tr_b16 a[56:57], v35 offset:2048
    ds_read_b64_tr_b16 a[58:59], v35 offset:2560
    ds_read_b128 a[60:63], v27 offset:0
    buffer_load_dwordx4 v14, s[12:15], s4 offen offset:2048 lds
    buffer_load_dwordx4 v15, s[12:15], s4 offen offset:3072 lds
    s_add_u32 s5, s98, 3
    s_and_b32 s5, s5, 7
    s_lshl_b32 s5, s5, 8
    s_add_u32 s5, s5, s21
    s_add_u32 m0, s23, 102400
    v_mfma_f32_16x16x32_bf16 v[76:79], a[12:15], a[0:3], v[124:127]
    ds_read_b64_tr_b16 a[64:65], v32 offset:18432
    ds_read_b64_tr_b16 a[66:67], v32 offset:18944
    v_mfma_f32_16x16x32_bf16 v[80:83], a[16:19], a[0:3], v[128:131]
    ds_read_b64_tr_b16 a[68:69], v33 offset:18432
    ds_read_b64_tr_b16 a[70:71], v33 offset:18944
    s_waitcnt lgkmcnt(14)
    v_mfma_f32_16x16x32_bf16 v[68:71], a[24:27], a[20:23], v[68:71]
    ds_read_b64_tr_b16 a[72:73], v34 offset:18432
    buffer_load_dwordx4 v20, s[8:11], s5 offen offset:0 lds
    buffer_load_dwordx4 v21, s[8:11], s5 offen offset:1024 lds
    v_mfma_f32_16x16x32_bf16 v[72:75], a[28:31], a[20:23], v[72:75]
    ds_read_b64_tr_b16 a[74:75], v34 offset:18944
    ds_read_b64_tr_b16 a[76:77], v35 offset:18432
    v_mfma_f32_16x16x32_bf16 v[76:79], a[32:35], a[20:23], v[76:79]
    ds_read_b64_tr_b16 a[78:79], v35 offset:18944
    v_mfma_f32_16x16x32_bf16 v[80:83], a[36:39], a[20:23], v[80:83]
    buffer_load_dwordx4 v22, s[8:11], s5 offen offset:2048 lds
    buffer_load_dwordx4 v23, s[8:11], s5 offen offset:3072 lds
    s_add_u32 s4, s98, 4
    s_and_b32 s4, s4, 7
    s_lshl_b32 s4, s4, 18
    s_add_u32 s4, s4, s22
    s_add_u32 m0, s23, 0
    s_waitcnt vmcnt(16) lgkmcnt(0)
    s_barrier
    buffer_load_dwordx4 v12, s[12:15], s4 offen offset:0 lds
    s_cmp_lg_u32 s36, 1
    s_cbranch_scc1 L_xt_3
    v_add_u32 v212, 32768, v55
    v_xor_b32 v213, 32, v212
    v_xor_b32 v214, 64, v212
    v_xor_b32 v215, 96, v212
    ds_read_b64 v[172:173], v212
    ds_read_b64 v[174:175], v213
    ds_read_b64 v[176:177], v214
    ds_read_b64 v[178:179], v215
L_xt_3:
    ds_read_b64 v[188:189], v63 offset:128
    ds_read_b64 v[190:191], v63 offset:160
    ds_read_b64 v[192:193], v63 offset:192
    ds_read_b64 v[194:195], v63 offset:224
    ds_read_b64 v[196:197], v63 offset:256
    ds_read_b64 v[198:199], v63 offset:288
    ds_read_b64 v[200:201], v63 offset:320
    ds_read_b64 v[202:203], v63 offset:352
    buffer_load_dwordx2 v[56:57], v54, s[44:47], 0 offen sc1
    v_mfma_f32_16x16x32_bf16 v[68:71], a[44:47], a[40:43], v[68:71]
    ds_read_b128 a[80:83], v24 offset:32768
    ds_read_b64_tr_b16 a[84:85], v32 offset:32768
    v_mfma_f32_16x16x32_bf16 v[72:75], a[48:51], a[40:43], v[72:75]
    ds_read_b64_tr_b16 a[86:87], v32 offset:33280
    ds_read_b64_tr_b16 a[88:89], v33 offset:32768
    ds_read_b64_tr_b16 a[90:91], v33 offset:33280
    ds_read_b64_tr_b16 a[92:93], v34 offset:32768
    buffer_load_dwordx4 v13, s[12:15], s4 offen offset:1024 lds
    v_mfma_f32_16x16x32_bf16 v[76:79], a[52:55], a[40:43], v[76:79]
    ds_read_b64_tr_b16 a[94:95], v34 offset:33280
    ds_read_b64_tr_b16 a[96:97], v35 offset:32768
    v_mfma_f32_16x16x32_bf16 v[80:83], a[56:59], a[40:43], v[80:83]
    ds_read_b64_tr_b16 a[98:99], v35 offset:33280
    ds_read_b128 a[100:103], v25 offset:32768
    ds_read_b64_tr_b16 a[104:105], v32 offset:49152
    ds_read_b64_tr_b16 a[106:107], v32 offset:49664
    buffer_load_dwordx4 v14, s[12:15], s4 offen offset:2048 lds
    v_mfma_f32_16x16x32_bf16 v[68:71], a[64:67], a[60:63], v[68:71]
    ds_read_b64_tr_b16 a[108:109], v33 offset:49152
    ds_read_b64_tr_b16 a[110:111], v33 offset:49664
    v_mfma_f32_16x16x32_bf16 v[72:75], a[68:71], a[60:63], v[72:75]
    ds_read_b64_tr_b16 a[112:113], v34 offset:49152
    ds_read_b64_tr_b16 a[114:115], v34 offset:49664
    ds_read_b64_tr_b16 a[116:117], v35 offset:49152
    ds_read_b64_tr_b16 a[118:119], v35 offset:49664
    s_waitcnt lgkmcnt(15)
    v_lshlrev_b32 v132, 16, v188
    v_and_b32 v133, 0xffff0000, v188
    v_lshlrev_b32 v134, 16, v189
    v_and_b32 v135, 0xffff0000, v189
    v_lshlrev_b32 v136, 16, v190
    v_and_b32 v137, 0xffff0000, v190
    v_lshlrev_b32 v138, 16, v191
    v_and_b32 v139, 0xffff0000, v191
    buffer_load_dwordx4 v15, s[12:15], s4 offen offset:3072 lds
    s_add_u32 s5, s98, 4
    s_and_b32 s5, s5, 7
    s_lshl_b32 s5, s5, 8
    s_add_u32 s5, s5, s21
    s_add_u32 m0, s23, 4096
    v_mfma_f32_16x16x32_bf16 v[76:79], a[72:75], a[60:63], v[76:79]
    ds_read_b128 a[120:123], v26 offset:32768
    ds_read_b64_tr_b16 a[124:125], v32 offset:34816
    v_mfma_f32_16x16x32_bf16 v[80:83], a[76:79], a[60:63], v[80:83]
    ds_read_b64_tr_b16 a[126:127], v32 offset:35328
    ds_read_b64_tr_b16 a[128:129], v33 offset:34816
    ds_read_b64_tr_b16 a[130:131], v33 offset:35328
    v_lshlrev_b32 v140, 16, v192
    v_and_b32 v141, 0xffff0000, v192
    v_lshlrev_b32 v142, 16, v193
    v_and_b32 v143, 0xffff0000, v193
    v_lshlrev_b32 v144, 16, v194
    v_and_b32 v145, 0xffff0000, v194
    v_lshlrev_b32 v146, 16, v195
    v_and_b32 v147, 0xffff0000, v195
    buffer_load_dwordx4 v20, s[8:11], s5 offen offset:0 lds
    s_waitcnt lgkmcnt(14)
    v_mfma_f32_16x16x32_bf16 v[68:71], a[84:87], a[80:83], v[68:71]
    ds_read_b64_tr_b16 a[132:133], v34 offset:34816
    ds_read_b64_tr_b16 a[134:135], v34 offset:35328
    v_mfma_f32_16x16x32_bf16 v[72:75], a[88:91], a[80:83], v[72:75]
    ds_read_b64_tr_b16 a[136:137], v35 offset:34816
    ds_read_b64_tr_b16 a[138:139], v35 offset:35328
    ds_read_b128 a[140:143], v27 offset:32768
    v_lshlrev_b32 v148, 16, v196
    v_and_b32 v149, 0xffff0000, v196
    v_lshlrev_b32 v150, 16, v197
    v_and_b32 v151, 0xffff0000, v197
    v_lshlrev_b32 v152, 16, v198
    v_and_b32 v153, 0xffff0000, v198
    v_lshlrev_b32 v154, 16, v199
    v_and_b32 v155, 0xffff0000, v199
    buffer_load_dwordx4 v21, s[8:11], s5 offen offset:1024 lds
    v_mfma_f32_16x16x32_bf16 v[76:79], a[92:95], a[80:83], v[76:79]
    ds_read_b64_tr_b16 a[144:145], v32 offset:51200
    ds_read_b64_tr_b16 a[146:147], v32 offset:51712
    v_mfma_f32_16x16x32_bf16 v[80:83], a[96:99], a[80:83], v[80:83]
    ds_read_b64_tr_b16 a[148:149], v33 offset:51200
    ds_read_b64_tr_b16 a[150:151], v33 offset:51712
    s_waitcnt lgkmcnt(14)
    v_mfma_f32_16x16x32_bf16 v[68:71], a[104:107], a[100:103], v[68:71]
    ds_read_b64_tr_b16 a[152:153], v34 offset:51200
    v_lshlrev_b32 v156, 16, v200
    v_and_b32 v157, 0xffff0000, v200
    v_lshlrev_b32 v158, 16, v201
    v_and_b32 v159, 0xffff0000, v201
    v_lshlrev_b32 v160, 16, v202
    v_and_b32 v161, 0xffff0000, v202
    v_lshlrev_b32 v162, 16, v203
    v_and_b32 v163, 0xffff0000, v203
    buffer_load_dwordx4 v22, s[8:11], s5 offen offset:2048 lds
    v_mfma_f32_16x16x32_bf16 v[72:75], a[108:111], a[100:103], v[72:75]
    ds_read_b64_tr_b16 a[154:155], v34 offset:51712
    ds_read_b64_tr_b16 a[156:157], v35 offset:51200
    v_mfma_f32_16x16x32_bf16 v[76:79], a[112:115], a[100:103], v[76:79]
    ds_read_b64_tr_b16 a[158:159], v35 offset:51712
    v_mfma_f32_16x16x32_bf16 v[80:83], a[116:119], a[100:103], v[80:83]
    buffer_load_dwordx4 v23, s[8:11], s5 offen offset:3072 lds
    s_add_u32 s4, s98, 5
    s_and_b32 s4, s4, 7
    s_lshl_b32 s4, s4, 18
    s_add_u32 s4, s4, s22
    s_add_u32 m0, s23, 32768
    s_waitcnt vmcnt(17) lgkmcnt(0)
    s_barrier
    buffer_load_dwordx4 v12, s[12:15], s4 offen offset:0 lds
    s_cmp_lg_u32 s36, 2
    s_cbranch_scc1 L_xt_4
    v_add_u32 v212, 65536, v55
    v_xor_b32 v213, 32, v212
    v_xor_b32 v214, 64, v212
    v_xor_b32 v215, 96, v212
    ds_read_b64 v[172:173], v212
    ds_read_b64 v[174:175], v213
    ds_read_b64 v[176:177], v214
    ds_read_b64 v[178:179], v215
L_xt_4:
    v_mfma_f32_16x16x32_bf16 v[68:71], a[124:127], a[120:123], v[68:71]
    ds_read_b128 a[0:3], v28 offset:0
    ds_read_b64_tr_b16 a[4:5], v36 offset:0
    v_mfma_f32_16x16x32_bf16 v[72:75], a[128:131], a[120:123], v[72:75]
    ds_read_b64_tr_b16 a[6:7], v36 offset:512
    ds_read_b64_tr_b16 a[8:9], v37 offset:0
    ds_read_b64_tr_b16 a[10:11], v37 offset:512
    ds_read_b64_tr_b16 a[12:13], v38 offset:0
    buffer_load_dwordx4 v13, s[12:15], s4 offen offset:1024 lds
    v_mfma_f32_16x16x32_bf16 v[76:79], a[132:135], a[120:123], v[76:79]
    ds_read_b64_tr_b16 a[14:15], v38 offset:512
    ds_read_b64_tr_b16 a[16:17], v39 offset:0
    v_mfma_f32_16x16x32_bf16 v[80:83], a[136:139], a[120:123], v[80:83]
    ds_read_b64_tr_b16 a[18:19], v39 offset:512
    ds_read_b128 a[20:23], v29 offset:0
    ds_read_b64_tr_b16 a[24:25], v36 offset:16384
    ds_read_b64_tr_b16 a[26:27], v36 offset:16896
    buffer_load_dwordx4 v14, s[12:15], s4 offen offset:2048 lds
    v_mfma_f32_16x16x32_bf16 v[68:71], a[144:147], a[140:143], v[68:71]
    ds_read_b64_tr_b16 a[28:29], v37 offset:16384
    ds_read_b64_tr_b16 a[30:31], v37 offset:16896
    v_mfma_f32_16x16x32_bf16 v[72:75], a[148:151], a[140:143], v[72:75]
    ds_read_b64_tr_b16 a[32:33], v38 offset:16384
    ds_read_b64_tr_b16 a[34:35], v38 offset:16896
    ds_read_b64_tr_b16 a[36:37], v39 offset:16384
    ds_read_b64_tr_b16 a[38:39], v39 offset:16896
    buffer_load_dwordx4 v15, s[12:15], s4 offen offset:3072 lds
    s_add_u32 s5, s98, 5
    s_and_b32 s5, s5, 7
    s_lshl_b32 s5, s5, 8
    s_add_u32 s5, s5, s21
    s_add_u32 m0, s23, 36864
    v_mfma_f32_16x16x32_bf16 v[76:79], a[152:155], a[140:143], v[76:79]
    ds_read_b128 a[40:43], v30 offset:0
    ds_read_b64_tr_b16 a[44:45], v36 offset:2048
    v_mfma_f32_16x16x32_bf16 v[80:83], a[156:159], a[140:143], v[80:83]
    ds_read_b64_tr_b16 a[46:47], v36 offset:2560
    ds_read_b64_tr_b16 a[48:49], v37 offset:2048
    ds_read_b64_tr_b16 a[50:51], v37 offset:2560
    buffer_load_dwordx4 v20, s[8:11], s5 offen offset:0 lds
    s_waitcnt lgkmcnt(14)
    v_mfma_f32_16x16x32_bf16 v[68:71], a[4:7], a[0:3], v[68:71]
    ds_read_b64_tr_b16 a[52:53], v38 offset:2048
    ds_read_b64_tr_b16 a[54:55], v38 offset:2560
    v_mfma_f32_16x16x32_bf16 v[72:75], a[8:11], a[0:3], v[72:75]
    ds_read_b64_tr_b16 a[56:57], v39 offset:2048
    ds_read_b64_tr_b16 a[58:59], v39 offset:2560
    ds_read_b128 a[60:63], v31 offset:0
    buffer_load_dwordx4 v21, s[8:11], s5 offen offset:1024 lds
    v_mfma_f32_16x16x32_bf16 v[76:79], a[12:15], a[0:3], v[76:79]
    ds_read_b64_tr_b16 a[64:65], v36 offset:18432
    ds_read_b64_tr_b16 a[66:67], v36 offset:18944
    v_mfma_f32_16x16x32_bf16 v[80:83], a[16:19], a[0:3], v[80:83]
    ds_read_b64_tr_b16 a[68:69], v37 offset:18432
    ds_read_b64_tr_b16 a[70:71], v37 offset:18944
    s_waitcnt lgkmcnt(14)
    v_mfma_f32_16x16x32_bf16 v[68:71], a[24:27], a[20:23], v[68:71]
    ds_read_b64_tr_b16 a[72:73], v38 offset:18432
    buffer_load_dwordx4 v22, s[8:11], s5 offen offset:2048 lds
    v_mfma_f32_16x16x32_bf16 v[72:75], a[28:31], a[20:23], v[72:75]
    ds_read_b64_tr_b16 a[74:75], v38 offset:18944
    ds_read_b64_tr_b16 a[76:77], v39 offset:18432
    v_mfma_f32_16x16x32_bf16 v[76:79], a[32:35], a[20:23], v[76:79]
    ds_read_b64_tr_b16 a[78:79], v39 offset:18944
    v_mfma_f32_16x16x32_bf16 v[80:83], a[36:39], a[20:23], v[80:83]
    buffer_load_dwordx4 v23, s[8:11], s5 offen offset:3072 lds
    s_add_u32 s4, s98, 6
    s_and_b32 s4, s4, 7
    s_lshl_b32 s4, s4, 18
    s_add_u32 s4, s4, s22
    s_add_u32 m0, s23, 65536
    s_waitcnt vmcnt(17) lgkmcnt(0)
    s_barrier
    buffer_load_dwordx4 v12, s[12:15], s4 offen offset:0 lds
    s_cmp_lg_u32 s36, 3
    s_cbranch_scc1 L_xt_5
    v_add_u32 v212, 98304, v55
    v_xor_b32 v213, 32, v212
    v_xor_b32 v214, 64, v212
    v_xor_b32 v215, 96, v212
    ds_read_b64 v[172:173], v212
    ds_read_b64 v[174:175], v213
    ds_read_b64 v[176:177], v214
    ds_read_b64 v[178:179], v215
L_xt_5:
    v_mfma_f32_16x16x32_bf16 v[68:71], a[44:47], a[40:43], v[68:71]
    ds_read_b128 a[80:83], v28 offset:32768
    ds_read_b64_tr_b16 a[84:85], v36 offset:32768
    v_mfma_f32_16x16x32_bf16 v[72:75], a[48:51], a[40:43], v[72:75]
    ds_read_b64_tr_b16 a[86:87], v36 offset:33280
    ds_read_b64_tr_b16 a[88:89], v37 offset:32768
    ds_read_b64_tr_b16 a[90:91], v37 offset:33280
    ds_read_b64_tr_b16 a[92:93], v38 offset:32768
    buffer_load_dwordx4 v13, s[12:15], s4 offen offset:1024 lds
    v_mfma_f32_16x16x32_bf16 v[76:79], a[52:55], a[40:43], v[76:79]
    ds_read_b64_tr_b16 a[94:95], v38 offset:33280
    ds_read_b64_tr_b16 a[96:97], v39 offset:32768
    v_mfma_f32_16x16x32_bf16 v[80:83], a[56:59], a[40:43], v[80:83]
    ds_read_b64_tr_b16 a[98:99], v39 offset:33280
    ds_read_b128 a[100:103], v29 offset:32768
    ds_read_b64_tr_b16 a[104:105], v36 offset:49152
    ds_read_b64_tr_b16 a[106:107], v36 offset:49664
    buffer_load_dwordx4 v14, s[12:15], s4 offen offset:2048 lds
    v_mfma_f32_16x16x32_bf16 v[68:71], a[64:67], a[60:63], v[68:71]
    ds_read_b64_tr_b16 a[108:109], v37 offset:49152
    ds_read_b64_tr_b16 a[110:111], v37 offset:49664
    v_mfma_f32_16x16x32_bf16 v[72:75], a[68:71], a[60:63], v[72:75]
    ds_read_b64_tr_b16 a[112:113], v38 offset:49152
    ds_read_b64_tr_b16 a[114:115], v38 offset:49664
    ds_read_b64_tr_b16 a[116:117], v39 offset:49152
    ds_read_b64_tr_b16 a[118:119], v39 offset:49664
    buffer_load_dwordx4 v15, s[12:15], s4 offen offset:3072 lds
    s_add_u32 s5, s98, 6
    s_and_b32 s5, s5, 7
    s_lshl_b32 s5, s5, 8
    s_add_u32 s5, s5, s21
    s_add_u32 m0, s23, 69632
    v_mfma_f32_16x16x32_bf16 v[76:79], a[72:75], a[60:63], v[76:79]
    ds_read_b128 a[120:123], v30 offset:32768
    ds_read_b64_tr_b16 a[124:125], v36 offset:34816
    v_mfma_f32_16x16x32_bf16 v[80:83], a[76:79], a[60:63], v[80:83]
    ds_read_b64_tr_b16 a[126:127], v36 offset:35328
    ds_read_b64_tr_b16 a[128:129], v37 offset:34816
    ds_read_b64_tr_b16 a[130:131], v37 offset:35328
    buffer_load_dwordx4 v20, s[8:11], s5 offen offset:0 lds
    s_waitcnt lgkmcnt(14)
    v_mfma_f32_16x16x32_bf16 v[68:71], a[84:87], a[80:83], v[68:71]
    ds_read_b64_tr_b16 a[132:133], v38 offset:34816
    ds_read_b64_tr_b16 a[134:135], v38 offset:35328
    v_mfma_f32_16x16x32_bf16 v[72:75], a[88:91], a[80:83], v[72:75]
    ds_read_b64_tr_b16 a[136:137], v39 offset:34816
    ds_read_b64_tr_b16 a[138:139], v39 offset:35328
    ds_read_b128 a[140:143], v31 offset:32768
    buffer_load_dwordx4 v21, s[8:11], s5 offen offset:1024 lds
    v_mfma_f32_16x16x32_bf16 v[76:79], a[92:95], a[80:83], v[76:79]
    ds_read_b64_tr_b16 a[144:145], v36 offset:51200
    ds_read_b64_tr_b16 a[146:147], v36 offset:51712
    v_mfma_f32_16x16x32_bf16 v[80:83], a[96:99], a[80:83], v[80:83]
    ds_read_b64_tr_b16 a[148:149], v37 offset:51200
    ds_read_b64_tr_b16 a[150:151], v37 offset:51712
    s_waitcnt lgkmcnt(14)
    v_mfma_f32_16x16x32_bf16 v[68:71], a[104:107], a[100:103], v[68:71]
    ds_read_b64_tr_b16 a[152:153], v38 offset:51200
    buffer_load_dwordx4 v22, s[8:11], s5 offen offset:2048 lds
    v_mfma_f32_16x16x32_bf16 v[72:75], a[108:111], a[100:103], v[72:75]
    ds_read_b64_tr_b16 a[154:155], v38 offset:51712
    ds_read_b64_tr_b16 a[156:157], v39 offset:51200
    v_mfma_f32_16x16x32_bf16 v[76:79], a[112:115], a[100:103], v[76:79]
    ds_read_b64_tr_b16 a[158:159], v39 offset:51712
    v_mfma_f32_16x16x32_bf16 v[80:83], a[116:119], a[100:103], v[80:83]
    buffer_load_dwordx4 v23, s[8:11], s5 offen offset:3072 lds
    s_add_u32 s5, s98, 7
    s_and_b32 s5, s5, 7
    s_lshl_b32 s5, s5, 8
    s_add_u32 s5, s5, s21
    s_add_u32 m0, s23, 102400
    s_waitcnt vmcnt(16) lgkmcnt(0)
    s_barrier
    buffer_load_dwordx4 v20, s[8:11], s5 offen offset:0 lds
    s_cmp_lg_u32 s36, 4
    s_cbranch_scc1 L_xt_6
    v_add_u32 v212, 0, v55
    v_xor_b32 v213, 32, v212
    v_xor_b32 v214, 64, v212
    v_xor_b32 v215, 96, v212
    ds_read_b64 v[172:173], v212
    ds_read_b64 v[174:175], v213
    ds_read_b64 v[176:177], v214
    ds_read_b64 v[178:179], v215
L_xt_6:
    v_mfma_f32_16x16x32_bf16 v[68:71], a[124:127], a[120:123], v[68:71]
    ds_read_b128 a[0:3], v24 offset:0
    ds_read_b64_tr_b16 a[4:5], v32 offset:0
    v_mfma_f32_16x16x32_bf16 v[72:75], a[128:131], a[120:123], v[72:75]
    ds_read_b64_tr_b16 a[6:7], v32 offset:512
    ds_read_b64_tr_b16 a[8:9], v33 offset:0
    ds_read_b64_tr_b16 a[10:11], v33 offset:512
    ds_read_b64_tr_b16 a[12:13], v34 offset:0
    buffer_load_dwordx4 v21, s[8:11], s5 offen offset:1024 lds
    v_mfma_f32_16x16x32_bf16 v[76:79], a[132:135], a[120:123], v[76:79]
    ds_read_b64_tr_b16 a[14:15], v34 offset:512
    ds_read_b64_tr_b16 a[16:17], v35 offset:0
    v_mfma_f32_16x16x32_bf16 v[80:83], a[136:139], a[120:123], v[80:83]
    ds_read_b64_tr_b16 a[18:19], v35 offset:512
    ds_read_b128 a[20:23], v25 offset:0
    ds_read_b64_tr_b16 a[24:25], v32 offset:16384
    ds_read_b64_tr_b16 a[26:27], v32 offset:16896
    buffer_load_dwordx4 v22, s[8:11], s5 offen offset:2048 lds
    v_mfma_f32_16x16x32_bf16 v[68:71], a[144:147], a[140:143], v[68:71]
    ds_read_b64_tr_b16 a[28:29], v33 offset:16384
    ds_read_b64_tr_b16 a[30:31], v33 offset:16896
    v_mfma_f32_16x16x32_bf16 v[72:75], a[148:151], a[140:143], v[72:75]
    ds_read_b64_tr_b16 a[32:33], v34 offset:16384
    ds_read_b64_tr_b16 a[34:35], v34 offset:16896
    ds_read_b64_tr_b16 a[36:37], v35 offset:16384
    ds_read_b64_tr_b16 a[38:39], v35 offset:16896
    buffer_load_dwordx4 v23, s[8:11], s5 offen offset:3072 lds
    s_add_u32 s4, s98, 7
    s_and_b32 s4, s4, 7
    s_lshl_b32 s4, s4, 18
    s_add_u32 s4, s4, s22
    s_add_u32 m0, s23, 98304
    v_mfma_f32_16x16x32_bf16 v[76:79], a[152:155], a[140:143], v[76:79]
    ds_read_b128 a[40:43], v26 offset:0
    ds_read_b64_tr_b16 a[44:45], v32 offset:2048
    v_mfma_f32_16x16x32_bf16 v[80:83], a[156:159], a[140:143], v[80:83]
    ds_read_b64_tr_b16 a[46:47], v32 offset:2560
    ds_read_b64_tr_b16 a[48:49], v33 offset:2048
    ds_read_b64_tr_b16 a[50:51], v33 offset:2560
    buffer_load_dwordx4 v12, s[12:15], s4 offen offset:0 lds
    s_waitcnt lgkmcnt(14)
    v_mfma_f32_16x16x32_bf16 v[68:71], a[4:7], a[0:3], v[68:71]
    ds_read_b64_tr_b16 a[52:53], v34 offset:2048
    ds_read_b64_tr_b16 a[54:55], v34 offset:2560
    v_mfma_f32_16x16x32_bf16 v[72:75], a[8:11], a[0:3], v[72:75]
    ds_read_b64_tr_b16 a[56:57], v35 offset:2048
    ds_read_b64_tr_b16 a[58:59], v35 offset:2560
    ds_read_b128 a[60:63], v27 offset:0
    buffer_load_dwordx4 v13, s[12:15], s4 offen offset:1024 lds
    v_mfma_f32_16x16x32_bf16 v[76:79], a[12:15], a[0:3], v[76:79]
    ds_read_b64_tr_b16 a[64:65], v32 offset:18432
    ds_read_b64_tr_b16 a[66:67], v32 offset:18944
    v_mfma_f32_16x16x32_bf16 v[80:83], a[16:19], a[0:3], v[80:83]
    ds_read_b64_tr_b16 a[68:69], v33 offset:18432
    ds_read_b64_tr_b16 a[70:71], v33 offset:18944
    s_waitcnt lgkmcnt(14)
    v_mfma_f32_16x16x32_bf16 v[68:71], a[24:27], a[20:23], v[68:71]
    ds_read_b64_tr_b16 a[72:73], v34 offset:18432
    buffer_load_dwordx4 v14, s[12:15], s4 offen offset:2048 lds
    v_mfma_f32_16x16x32_bf16 v[72:75], a[28:31], a[20:23], v[72:75]
    ds_read_b64_tr_b16 a[74:75], v34 offset:18944
    ds_read_b64_tr_b16 a[76:77], v35 offset:18432
    v_mfma_f32_16x16x32_bf16 v[76:79], a[32:35], a[20:23], v[76:79]
    ds_read_b64_tr_b16 a[78:79], v35 offset:18944
    v_mfma_f32_16x16x32_bf16 v[80:83], a[36:39], a[20:23], v[80:83]
    buffer_load_dwordx4 v15, s[12:15], s4 offen offset:3072 lds
    s_add_u32 s4, s99, 0
    s_and_b32 s4, s4, 7
    s_lshl_b32 s4, s4, 18
    s_add_u32 s4, s4, s22
    s_add_u32 s4, s4, 2097152
    s_add_u32 m0, s23, 0
    s_waitcnt vmcnt(16) lgkmcnt(0)
    s_barrier
    s_cmp_lg_u32 s3, 3
    s_cbranch_scc1 L_help_7
    s_add_u32 s20, s37, 2097536
    s_mov_b64 exec, 0xffffffff
    buffer_load_dword v67, v66, s[12:15], s20 offen
    s_mov_b64 exec, -1
L_help_7:
    buffer_load_dwordx4 v16, s[12:15], s4 offen offset:0 lds
    s_cmp_lg_u32 s36, 5
    s_cbranch_scc1 L_xt_8
    v_add_u32 v212, 32768, v55
    v_xor_b32 v213, 32, v212
    v_xor_b32 v214, 64, v212
    v_xor_b32 v215, 96, v212
    ds_read_b64 v[172:173], v212
    ds_read_b64 v[174:175], v213
    ds_read_b64 v[176:177], v214
    ds_read_b64 v[178:179], v215
L_xt_8:
    v_mfma_f32_16x16x32_bf16 v[68:71], a[44:47], a[40:43], v[68:71]
    ds_read_b128 a[80:83], v24 offset:32768
    ds_read_b64_tr_b16 a[84:85], v32 offset:32768
    v_mfma_f32_16x16x32_bf16 v[72:75], a[48:51], a[40:43], v[72:75]
    ds_read_b64_tr_b16 a[86:87], v32 offset:33280
    ds_read_b64_tr_b16 a[88:89], v33 offset:32768
    ds_read_b64_tr_b16 a[90:91], v33 offset:33280
    ds_read_b64_tr_b16 a[92:93], v34 offset:32768
    buffer_load_dwordx4 v17, s[12:15], s4 offen offset:1024 lds
    v_mfma_f32_16x16x32_bf16 v[76:79], a[52:55], a[40:43], v[76:79]
    ds_read_b64_tr_b16 a[94:95], v34 offset:33280
    ds_read_b64_tr_b16 a[96:97], v35 offset:32768
    v_mfma_f32_16x16x32_bf16 v[80:83], a[56:59], a[40:43], v[80:83]
    ds_read_b64_tr_b16 a[98:99], v35 offset:33280
    ds_read_b128 a[100:103], v25 offset:32768
    ds_read_b64_tr_b16 a[104:105], v32 offset:49152
    ds_read_b64_tr_b16 a[106:107], v32 offset:49664
    buffer_load_dwordx4 v18, s[12:15], s4 offen offset:2048 lds
    v_mfma_f32_16x16x32_bf16 v[68:71], a[64:67], a[60:63], v[68:71]
    ds_read_b64_tr_b16 a[108:109], v33 offset:49152
    ds_read_b64_tr_b16 a[110:111], v33 offset:49664
    v_mfma_f32_16x16x32_bf16 v[72:75], a[68:71], a[60:63], v[72:75]
    ds_read_b64_tr_b16 a[112:113], v34 offset:49152
    ds_read_b64_tr_b16 a[114:115], v34 offset:49664
    ds_read_b64_tr_b16 a[116:117], v35 offset:49152
    ds_read_b64_tr_b16 a[118:119], v35 offset:49664
    buffer_load_dwordx4 v19, s[12:15], s4 offen offset:3072 lds
    s_add_u32 s4, s99, 1
    s_and_b32 s4, s4, 7
    s_lshl_b32 s4, s4, 18
    s_add_u32 s4, s4, s22
    s_add_u32 s4, s4, 2097152
    s_add_u32 m0, s23, 4096
    v_mfma_f32_16x16x32_bf16 v[76:79], a[72:75], a[60:63], v[76:79]
    ds_read_b128 a[120:123], v26 offset:32768
    ds_read_b64_tr_b16 a[124:125], v32 offset:34816
    v_mfma_f32_16x16x32_bf16 v[80:83], a[76:79], a[60:63], v[80:83]
    ds_read_b64_tr_b16 a[126:127], v32 offset:35328
    ds_read_b64_tr_b16 a[128:129], v33 offset:34816
    ds_read_b64_tr_b16 a[130:131], v33 offset:35328
    buffer_load_dwordx4 v16, s[12:15], s4 offen offset:0 lds
    s_waitcnt lgkmcnt(14)
    v_mfma_f32_16x16x32_bf16 v[68:71], a[84:87], a[80:83], v[68:71]
    ds_read_b64_tr_b16 a[132:133], v34 offset:34816
    ds_read_b64_tr_b16 a[134:135], v34 offset:35328
    v_mfma_f32_16x16x32_bf16 v[72:75], a[88:91], a[80:83], v[72:75]
    ds_read_b64_tr_b16 a[136:137], v35 offset:34816
    ds_read_b64_tr_b16 a[138:139], v35 offset:35328
    ds_read_b128 a[140:143], v27 offset:32768
    buffer_load_dwordx4 v17, s[12:15], s4 offen offset:1024 lds
    v_mfma_f32_16x16x32_bf16 v[76:79], a[92:95], a[80:83], v[76:79]
    ds_read_b64_tr_b16 a[144:145], v32 offset:51200
    ds_read_b64_tr_b16 a[146:147], v32 offset:51712
    v_mfma_f32_16x16x32_bf16 v[80:83], a[96:99], a[80:83], v[80:83]
    ds_read_b64_tr_b16 a[148:149], v33 offset:51200
    ds_read_b64_tr_b16 a[150:151], v33 offset:51712
    s_waitcnt lgkmcnt(14)
    v_mfma_f32_16x16x32_bf16 v[68:71], a[104:107], a[100:103], v[68:71]
    ds_read_b64_tr_b16 a[152:153], v34 offset:51200
    buffer_load_dwordx4 v18, s[12:15], s4 offen offset:2048 lds
    v_mfma_f32_16x16x32_bf16 v[72:75], a[108:111], a[100:103], v[72:75]
    ds_read_b64_tr_b16 a[154:155], v34 offset:51712
    ds_read_b64_tr_b16 a[156:157], v35 offset:51200
    v_mfma_f32_16x16x32_bf16 v[76:79], a[112:115], a[100:103], v[76:79]
    ds_read_b64_tr_b16 a[158:159], v35 offset:51712
    v_mfma_f32_16x16x32_bf16 v[80:83], a[116:119], a[100:103], v[80:83]
    buffer_load_dwordx4 v19, s[12:15], s4 offen offset:3072 lds
    s_add_u32 s4, s99, 2
    s_and_b32 s4, s4, 7
    s_lshl_b32 s4, s4, 18
    s_add_u32 s4, s4, s22
    s_add_u32 s4, s4, 2097152
    s_add_u32 m0, s23, 32768
    s_waitcnt vmcnt(16) lgkmcnt(0)
    s_barrier
    buffer_load_dwordx4 v16, s[12:15], s4 offen offset:0 lds
    s_cmp_lg_u32 s36, 6
    s_cbranch_scc1 L_xt_9
    v_add_u32 v212, 65536, v55
    v_xor_b32 v213, 32, v212
    v_xor_b32 v214, 64, v212
    v_xor_b32 v215, 96, v212
    ds_read_b64 v[172:173], v212
    ds_read_b64 v[174:175], v213
    ds_read_b64 v[176:177], v214
    ds_read_b64 v[178:179], v215
L_xt_9:
    v_mfma_f32_16x16x32_bf16 v[68:71], a[124:127], a[120:123], v[68:71]
    ds_read_b128 a[0:3], v28 offset:0
    ds_read_b64_tr_b16 a[4:5], v36 offset:0
    v_mfma_f32_16x16x32_bf16 v[72:75], a[128:131], a[120:123], v[72:75]
    ds_read_b64_tr_b16 a[6:7], v36 offset:512
    ds_read_b64_tr_b16 a[8:9], v37 offset:0
    ds_read_b64_tr_b16 a[10:11], v37 offset:512
    ds_read_b64_tr_b16 a[12:13], v38 offset:0
    buffer_load_dwordx4 v17, s[12:15], s4 offen offset:1024 lds
    v_mfma_f32_16x16x32_bf16 v[76:79], a[132:135], a[120:123], v[76:79]
    ds_read_b64_tr_b16 a[14:15], v38 offset:512
    ds_read_b64_tr_b16 a[16:17], v39 offset:0
    v_mfma_f32_16x16x32_bf16 v[80:83], a[136:139], a[120:123], v[80:83]
    ds_read_b64_tr_b16 a[18:19], v39 offset:512
    ds_read_b128 a[20:23], v29 offset:0
    ds_read_b64_tr_b16 a[24:25], v36 offset:16384
    ds_read_b64_tr_b16 a[26:27], v36 offset:16896
    buffer_load_dwordx4 v18, s[12:15], s4 offen offset:2048 lds
    v_mfma_f32_16x16x32_bf16 v[68:71], a[144:147], a[140:143], v[68:71]
    ds_read_b64_tr_b16 a[28:29], v37 offset:16384
    ds_read_b64_tr_b16 a[30:31], v37 offset:16896
    v_mfma_f32_16x16x32_bf16 v[72:75], a[148:151], a[140:143], v[72:75]
    ds_read_b64_tr_b16 a[32:33], v38 offset:16384
    ds_read_b64_tr_b16 a[34:35], v38 offset:16896
    ds_read_b64_tr_b16 a[36:37], v39 offset:16384
    ds_read_b64_tr_b16 a[38:39], v39 offset:16896
    buffer_load_dwordx4 v19, s[12:15], s4 offen offset:3072 lds
    s_add_u32 s4, s99, 3
    s_and_b32 s4, s4, 7
    s_lshl_b32 s4, s4, 18
    s_add_u32 s4, s4, s22
    s_add_u32 s4, s4, 2097152
    s_add_u32 m0, s23, 36864
    v_mfma_f32_16x16x32_bf16 v[76:79], a[152:155], a[140:143], v[76:79]
    ds_read_b128 a[40:43], v30 offset:0
    ds_read_b64_tr_b16 a[44:45], v36 offset:2048
    v_mfma_f32_16x16x32_bf16 v[80:83], a[156:159], a[140:143], v[80:83]
    ds_read_b64_tr_b16 a[46:47], v36 offset:2560
    ds_read_b64_tr_b16 a[48:49], v37 offset:2048
    ds_read_b64_tr_b16 a[50:51], v37 offset:2560
    buffer_load_dwordx4 v16, s[12:15], s4 offen offset:0 lds
    s_waitcnt lgkmcnt(14)
    v_mfma_f32_16x16x32_bf16 v[68:71], a[4:7], a[0:3], v[68:71]
    ds_read_b64_tr_b16 a[52:53], v38 offset:2048
    ds_read_b64_tr_b16 a[54:55], v38 offset:2560
    v_mfma_f32_16x16x32_bf16 v[72:75], a[8:11], a[0:3], v[72:75]
    ds_read_b64_tr_b16 a[56:57], v39 offset:2048
    ds_read_b64_tr_b16 a[58:59], v39 offset:2560
    ds_read_b128 a[60:63], v31 offset:0
    buffer_load_dwordx4 v17, s[12:15], s4 offen offset:1024 lds
    v_mfma_f32_16x16x32_bf16 v[76:79], a[12:15], a[0:3], v[76:79]
    ds_read_b64_tr_b16 a[64:65], v36 offset:18432
    ds_read_b64_tr_b16 a[66:67], v36 offset:18944
    v_mfma_f32_16x16x32_bf16 v[80:83], a[16:19], a[0:3], v[80:83]
    ds_read_b64_tr_b16 a[68:69], v37 offset:18432
    ds_read_b64_tr_b16 a[70:71], v37 offset:18944
    s_waitcnt lgkmcnt(14)
    v_mfma_f32_16x16x32_bf16 v[68:71], a[24:27], a[20:23], v[68:71]
    ds_read_b64_tr_b16 a[72:73], v38 offset:18432
    buffer_load_dwordx4 v18, s[12:15], s4 offen offset:2048 lds
    v_mfma_f32_16x16x32_bf16 v[72:75], a[28:31], a[20:23], v[72:75]
    ds_read_b64_tr_b16 a[74:75], v38 offset:18944
    ds_read_b64_tr_b16 a[76:77], v39 offset:18432
    v_mfma_f32_16x16x32_bf16 v[76:79], a[32:35], a[20:23], v[76:79]
    ds_read_b64_tr_b16 a[78:79], v39 offset:18944
    v_mfma_f32_16x16x32_bf16 v[80:83], a[36:39], a[20:23], v[80:83]
    buffer_load_dwordx4 v19, s[12:15], s4 offen offset:3072 lds
    s_waitcnt vmcnt(18) lgkmcnt(0)
    s_barrier
    s_cmp_lg_u32 s36, 7
    s_cbranch_scc1 L_xt_10
    v_add_u32 v212, 98304, v55
    v_xor_b32 v213, 32, v212
    v_xor_b32 v214, 64, v212
    v_xor_b32 v215, 96, v212
    ds_read_b64 v[172:173], v212
    ds_read_b64 v[174:175], v213
    ds_read_b64 v[176:177], v214
    ds_read_b64 v[178:179], v215
L_xt_10:
    v_mfma_f32_16x16x32_bf16 v[68:71], a[44:47], a[40:43], v[68:71]
    ds_read_b128 a[80:83], v28 offset:32768
    ds_read_b64_tr_b16 a[84:85], v36 offset:32768
    v_mfma_f32_16x16x32_bf16 v[72:75], a[48:51], a[40:43], v[72:75]
    ds_read_b64_tr_b16 a[86:87], v36 offset:33280
    ds_read_b64_tr_b16 a[88:89], v37 offset:32768
    s_add_u32 s4, s99, 4
    s_and_b32 s4, s4, 7
    s_lshl_b32 s4, s4, 18
    s_add_u32 s4, s4, s22
    s_add_u32 s4, s4, 2097152
    s_add_u32 m0, s23, 65536
    s_nop 0
    buffer_load_dwordx4 v16, s[12:15], s4 offen offset:0 lds
    v_mfma_f32_16x16x32_bf16 v[76:79], a[52:55], a[40:43], v[76:79]
    ds_read_b64_tr_b16 a[90:91], v37 offset:33280
    ds_read_b64_tr_b16 a[92:93], v38 offset:32768
    v_mfma_f32_16x16x32_bf16 v[80:83], a[56:59], a[40:43], v[80:83]
    ds_read_b64_tr_b16 a[94:95], v38 offset:33280
    ds_read_b64_tr_b16 a[96:97], v39 offset:32768
    v_mfma_f32_16x16x32_bf16 v[68:71], a[64:67], a[60:63], v[68:71]
    ds_read_b64_tr_b16 a[98:99], v39 offset:33280
    buffer_load_dwordx4 v17, s[12:15], s4 offen offset:1024 lds
    v_mfma_f32_16x16x32_bf16 v[72:75], a[68:71], a[60:63], v[72:75]
    ds_read_b128 a[100:103], v29 offset:32768
    ds_read_b64_tr_b16 a[104:105], v36 offset:49152
    v_mfma_f32_16x16x32_bf16 v[76:79], a[72:75], a[60:63], v[76:79]
    ds_read_b64_tr_b16 a[106:107], v36 offset:49664
    ds_read_b64_tr_b16 a[108:109], v37 offset:49152
    buffer_load_dwordx4 v18, s[12:15], s4 offen offset:2048 lds
    v_mfma_f32_16x16x32_bf16 v[80:83], a[76:79], a[60:63], v[80:83]
    ds_read_b64_tr_b16 a[110:111], v37 offset:49664
    ds_read_b64_tr_b16 a[112:113], v38 offset:49152
    s_waitcnt lgkmcnt(6)
    v_mfma_f32_16x16x32_bf16 v[68:71], a[84:87], a[80:83], v[68:71]
    ds_read_b64_tr_b16 a[114:115], v38 offset:49664
    ds_read_b64_tr_b16 a[116:117], v39 offset:49152
    v_mfma_f32_16x16x32_bf16 v[72:75], a[88:91], a[80:83], v[72:75]
    ds_read_b64_tr_b16 a[118:119], v39 offset:49664
    buffer_load_dwordx4 v19, s[12:15], s4 offen offset:3072 lds
    v_lshlrev_b32 v84, 16, v172
    v_and_b32 v85, 0xffff0000, v172
    v_lshlrev_b32 v86, 16, v173
    v_and_b32 v87, 0xffff0000, v173
    v_lshlrev_b32 v88, 16, v174
    v_and_b32 v89, 0xffff0000, v174
    v_lshlrev_b32 v90, 16, v175
    v_and_b32 v91, 0xffff0000, v175
    v_lshlrev_b32 v92, 16, v176
    v_and_b32 v93, 0xffff0000, v176
    v_lshlrev_b32 v94, 16, v177
    v_and_b32 v95, 0xffff0000, v177
    v_lshlrev_b32 v96, 16, v178
    v_and_b32 v97, 0xffff0000, v178
    v_lshlrev_b32 v98, 16, v179
    v_and_b32 v99, 0xffff0000, v179
    s_waitcnt vmcnt(20)
    s_barrier
    v_mfma_f32_16x16x32_bf16 v[76:79], a[92:95], a[80:83], v[76:79]
    ds_read_b128 a[120:123], v30 offset:32768
    ds_read_b64_tr_b16 a[124:125], v36 offset:34816
    v_mfma_f32_16x16x32_bf16 v[80:83], a[96:99], a[80:83], v[80:83]
    ds_read_b64_tr_b16 a[126:127], v36 offset:35328
    ds_read_b64_tr_b16 a[128:129], v37 offset:34816
    s_waitcnt lgkmcnt(4)
    v_mfma_f32_16x16x32_bf16 v[68:71], a[104:107], a[100:103], v[68:71]
    ds_read_b64_tr_b16 a[130:131], v37 offset:35328
    ds_read_b64_tr_b16 a[132:133], v38 offset:34816
    v_mfma_f32_16x16x32_bf16 v[72:75], a[108:111], a[100:103], v[72:75]
    ds_read_b64_tr_b16 a[134:135], v38 offset:35328
    ds_read_b64_tr_b16 a[136:137], v39 offset:34816
    v_mfma_f32_16x16x32_bf16 v[76:79], a[112:115], a[100:103], v[76:79]
    ds_read_b64_tr_b16 a[138:139], v39 offset:35328
    v_mfma_f32_16x16x32_bf16 v[80:83], a[116:119], a[100:103], v[80:83]
    ds_read_b128 a[140:143], v31 offset:32768
    ds_read_b64_tr_b16 a[144:145], v36 offset:51200
    ds_read_b64_tr_b16 a[146:147], v36 offset:51712
    ds_read_b64_tr_b16 a[148:149], v37 offset:51200
    ds_read_b64_tr_b16 a[150:151], v37 offset:51712
    ds_read_b64_tr_b16 a[152:153], v38 offset:51200
    ds_read_b64_tr_b16 a[154:155], v38 offset:51712
    ds_read_b64_tr_b16 a[156:157], v39 offset:51200
    ds_read_b64_tr_b16 a[158:159], v39 offset:51712
    s_waitcnt lgkmcnt(9)
    v_mfma_f32_16x16x32_bf16 v[68:71], a[124:127], a[120:123], v[68:71]
    v_mfma_f32_16x16x32_bf16 v[72:75], a[128:131], a[120:123], v[72:75]
    v_mfma_f32_16x16x32_bf16 v[76:79], a[132:135], a[120:123], v[76:79]
    v_mfma_f32_16x16x32_bf16 v[80:83], a[136:139], a[120:123], v[80:83]
    s_waitcnt lgkmcnt(0)
    v_mfma_f32_16x16x32_bf16 v[68:71], a[144:147], a[140:143], v[68:71]
    v_mfma_f32_16x16x32_bf16 v[72:75], a[148:151], a[140:143], v[72:75]
    v_mfma_f32_16x16x32_bf16 v[76:79], a[152:155], a[140:143], v[76:79]
    v_mfma_f32_16x16x32_bf16 v[80:83], a[156:159], a[140:143], v[80:83]
    s_nop 4
    v_pk_fma_f32 v[68:69], v[68:69], v[84:85], v[84:85]
    v_pk_fma_f32 v[70:71], v[70:71], v[86:87], v[86:87]
    v_cvt_pk_bf16_f32 v164, v68, v69
    v_cvt_pk_bf16_f32 v165, v70, v71
    v_pk_fma_f32 v[72:73], v[72:73], v[88:89], v[88:89]
    v_pk_fma_f32 v[74:75], v[74:75], v[90:91], v[90:91]
    v_cvt_pk_bf16_f32 v166, v72, v73
    v_cvt_pk_bf16_f32 v167, v74, v75
    buffer_store_dwordx4 v[164:167], v52, s[24:27], s58 offen offset:0 sc1
    v_pk_fma_f32 v[76:77], v[76:77], v[92:93], v[92:93]
    v_pk_fma_f32 v[78:79], v[78:79], v[94:95], v[94:95]
    v_cvt_pk_bf16_f32 v168, v76, v77
    v_cvt_pk_bf16_f32 v169, v78, v79
    v_pk_fma_f32 v[80:81], v[80:81], v[96:97], v[96:97]
    v_pk_fma_f32 v[82:83], v[82:83], v[98:99], v[98:99]
    v_cvt_pk_bf16_f32 v170, v80, v81
    v_cvt_pk_bf16_f32 v171, v82, v83
    buffer_store_dwordx4 v[168:171], v52, s[24:27], s58 offen offset:1024 sc1
    s_mov_b32 s35, 0
L_non_11:
    v_readfirstlane_b32 s32, v56
    v_readfirstlane_b32 s33, v57
    s_add_u32 s35, s35, 1
    s_cmp_lg_u32 s33, 0
    s_cbranch_scc1 L_non_11_ok
    buffer_load_dwordx2 v[56:57], v54, s[44:47], 0 offen sc1
    s_cmp_lt_u32 s35, 8388608
    s_waitcnt vmcnt(0)
    s_cbranch_scc1 L_non_11
L_non_11_ok:
    s_waitcnt vmcnt(6)
    s_barrier
    v_add_u32 v32, 140288, v40
    v_add_u32 v33, 140288, v41
    v_add_u32 v34, 140288, v42
    v_add_u32 v35, 140288, v43
    s_add_u32 s4, s99, 5
    s_and_b32 s4, s4, 7
    s_lshl_b32 s4, s4, 18
    s_add_u32 s4, s4, s22
    s_add_u32 s4, s4, 2097152
    s_add_u32 m0, s23, 69632
    s_nop 0
    buffer_load_dwordx4 v16, s[12:15], s4 offen offset:0 lds
    v_lshlrev_b32 v100, 16, v164
    v_and_b32 v101, 0xffff0000, v164
    v_lshlrev_b32 v102, 16, v165
    v_and_b32 v103, 0xffff0000, v165
    v_lshlrev_b32 v104, 16, v166
    v_and_b32 v105, 0xffff0000, v166
    v_lshlrev_b32 v106, 16, v167
    v_and_b32 v107, 0xffff0000, v167
    v_lshlrev_b32 v108, 16, v168
    v_and_b32 v109, 0xffff0000, v168
    v_lshlrev_b32 v110, 16, v169
    v_and_b32 v111, 0xffff0000, v169
    v_lshlrev_b32 v112, 16, v170
    v_and_b32 v113, 0xffff0000, v170
    v_lshlrev_b32 v114, 16, v171
    v_and_b32 v115, 0xffff0000, v171
    ds_read_b64_tr_b16 a[0:1], v40 offset:0
    ds_read_b64_tr_b16 a[2:3], v40 offset:8192
    ds_read_b64_tr_b16 a[4:5], v41 offset:0
    ds_read_b64_tr_b16 a[6:7], v41 offset:8192
    ds_read_b64_tr_b16 a[8:9], v42 offset:0
    ds_read_b64_tr_b16 a[10:11], v42 offset:8192
    ds_read_b64_tr_b16 a[12:13], v43 offset:0
    ds_read_b64_tr_b16 a[14:15], v43 offset:8192
    buffer_load_dwordx4 v17, s[12:15], s4 offen offset:1024 lds
    s_add_u32 s36, s99, 0
    s_and_b32 s36, s36, 7
    s_lshl_b32 s36, s36, 12
    s_add_u32 s36, s36, s59
    s_add_u32 s38, s99, 1
    s_and_b32 s38, s38, 7
    s_lshl_b32 s38, s38, 12
    s_add_u32 s38, s38, s59
    s_add_u32 s39, s99, 2
    s_and_b32 s39, s39, 7
    s_lshl_b32 s39, s39, 12
    s_add_u32 s39, s39, s59
    s_add_u32 s52, s99, 3
    s_and_b32 s52, s52, 7
    s_lshl_b32 s52, s52, 12
    s_add_u32 s52, s52, s59
    s_add_u32 s53, s99, 4
    s_and_b32 s53, s53, 7
    s_lshl_b32 s53, s53, 12
    s_add_u32 s53, s53, s59
    s_add_u32 s54, s99, 5
    s_and_b32 s54, s54, 7
    s_lshl_b32 s54, s54, 12
    s_add_u32 s54, s54, s59
    s_add_u32 s55, s99, 6
    s_and_b32 s55, s55, 7
    s_lshl_b32 s55, s55, 12
    s_add_u32 s55, s55, s59
    s_add_u32 s101, s99, 7
    s_and_b32 s101, s101, 7
    s_lshl_b32 s101, s101, 12
    s_add_u32 s101, s101, s59
    ds_read_b64_tr_b16 a[16:17], v40 offset:16384
    ds_read_b64_tr_b16 a[18:19], v40 offset:24576
    ds_read_b64_tr_b16 a[20:21], v41 offset:16384
    ds_read_b64_tr_b16 a[22:23], v41 offset:24576
    ds_read_b64_tr_b16 a[24:25], v42 offset:16384
    ds_read_b64_tr_b16 a[26:27], v42 offset:24576
    ds_read_b64_tr_b16 a[28:29], v43 offset:16384
    ds_read_b64_tr_b16 a[30:31], v43 offset:24576
    buffer_load_dwordx4 v18, s[12:15], s4 offen offset:2048 lds
    ds_read_b64_tr_b16 a[32:33], v40 offset:2048
    ds_read_b64_tr_b16 a[34:35], v40 offset:10240
    ds_read_b64_tr_b16 a[36:37], v41 offset:2048
    ds_read_b64_tr_b16 a[38:39], v41 offset:10240
    ds_read_b64_tr_b16 a[40:41], v42 offset:2048
    ds_read_b64_tr_b16 a[42:43], v42 offset:10240
    ds_read_b64_tr_b16 a[44:45], v43 offset:2048
    ds_read_b64_tr_b16 a[46:47], v43 offset:10240
    buffer_load_dwordx4 v19, s[12:15], s4 offen offset:3072 lds
    s_waitcnt vmcnt(4)
    s_mov_b64 exec, 1
    buffer_store_dwordx2 v[56:57], v54, s[24:27], s56 offen offset:0 sc1
    s_mov_b64 exec, -1
    ds_read_b64_tr_b16 a[48:49], v40 offset:18432
    ds_read_b64_tr_b16 a[50:51], v40 offset:26624
    ds_read_b64_tr_b16 a[52:53], v41 offset:18432
    ds_read_b64_tr_b16 a[54:55], v41 offset:26624
    ds_read_b64_tr_b16 a[56:57], v42 offset:18432
    ds_read_b64_tr_b16 a[58:59], v42 offset:26624
    ds_read_b64_tr_b16 a[60:61], v43 offset:18432
    ds_read_b64_tr_b16 a[62:63], v43 offset:26624
    s_cmp_lg_u32 s3, 3
    s_cbranch_scc1 L_help_12
    s_add_u32 s20, s37, 4194688
    s_mov_b64 exec, 0xffffffff
    buffer_load_dword v67, v66, s[12:15], s20 offen
    s_mov_b64 exec, -1
L_help_12:
    s_add_u32 s4, s100, 0
    s_and_b32 s4, s4, 7
    s_lshl_b32 s4, s4, 18
    s_add_u32 s4, s4, s22
    s_add_u32 s4, s4, 4194304
    s_lshr_b32 s7, s23, 1
    s_add_u32 m0, s7, 140288
    s_nop 0
    buffer_load_dwordx4 v16, s[12:15], s4 offen offset:0 lds
    ds_read_b64_tr_b16 a[64:65], v40 offset:4096
    ds_read_b64_tr_b16 a[66:67], v40 offset:12288
    ds_read_b64_tr_b16 a[68:69], v41 offset:4096
    ds_read_b64_tr_b16 a[70:71], v41 offset:12288
    ds_read_b64_tr_b16 a[72:73], v42 offset:4096
    ds_read_b64_tr_b16 a[74:75], v42 offset:12288
    ds_read_b64_tr_b16 a[76:77], v43 offset:4096
    ds_read_b64_tr_b16 a[78:79], v43 offset:12288
    buffer_load_dwordx4 v17, s[12:15], s4 offen offset:1024 lds
    ds_read_b64_tr_b16 a[80:81], v40 offset:20480
    ds_read_b64_tr_b16 a[82:83], v40 offset:28672
    ds_read_b64_tr_b16 a[84:85], v41 offset:20480
    ds_read_b64_tr_b16 a[86:87], v41 offset:28672
    ds_read_b64_tr_b16 a[88:89], v42 offset:20480
    ds_read_b64_tr_b16 a[90:91], v42 offset:28672
    ds_read_b64_tr_b16 a[92:93], v43 offset:20480
    ds_read_b64_tr_b16 a[94:95], v43 offset:28672
    buffer_load_dwordx4 v18, s[12:15], s4 offen offset:2048 lds
    ds_read_b64_tr_b16 a[96:97], v40 offset:6144
    ds_read_b64_tr_b16 a[98:99], v40 offset:14336
    ds_read_b64_tr_b16 a[100:101], v41 offset:6144
    ds_read_b64_tr_b16 a[102:103], v41 offset:14336
    ds_read_b64_tr_b16 a[104:105], v42 offset:6144
    ds_read_b64_tr_b16 a[106:107], v42 offset:14336
    ds_read_b64_tr_b16 a[108:109], v43 offset:6144
    ds_read_b64_tr_b16 a[110:111], v43 offset:14336
    buffer_load_dwordx4 v19, s[12:15], s4 offen offset:3072 lds
    ds_read_b64_tr_b16 a[112:113], v40 offset:22528
    ds_read_b64_tr_b16 a[114:115], v40 offset:30720
    ds_read_b64_tr_b16 a[116:117], v41 offset:22528
    ds_read_b64_tr_b16 a[118:119], v41 offset:30720
    ds_read_b64_tr_b16 a[120:121], v42 offset:22528
    ds_read_b64_tr_b16 a[122:123], v42 offset:30720
    ds_read_b64_tr_b16 a[124:125], v43 offset:22528
    ds_read_b64_tr_b16 a[126:127], v43 offset:30720
    s_add_u32 s4, s99, 6
    s_and_b32 s4, s4, 7
    s_lshl_b32 s4, s4, 18
    s_add_u32 s4, s4, s22
    s_add_u32 s4, s4, 2097152
    s_add_u32 m0, s23, 98304
    s_nop 0
    buffer_load_dwordx4 v16, s[12:15], s4 offen offset:0 lds
    ds_read_b64_tr_b16 a[128:129], v40 offset:32768
    ds_read_b64_tr_b16 a[130:131], v40 offset:40960
    ds_read_b64_tr_b16 a[132:133], v41 offset:32768
    ds_read_b64_tr_b16 a[134:135], v41 offset:40960
    ds_read_b64_tr_b16 a[136:137], v42 offset:32768
    ds_read_b64_tr_b16 a[138:139], v42 offset:40960
    ds_read_b64_tr_b16 a[140:141], v43 offset:32768
    ds_read_b64_tr_b16 a[142:143], v43 offset:40960
    buffer_load_dwordx4 v17, s[12:15], s4 offen offset:1024 lds
    ds_read_b64_tr_b16 a[144:145], v40 offset:49152
    ds_read_b64_tr_b16 a[146:147], v40 offset:57344
    ds_read_b64_tr_b16 a[148:149], v41 offset:49152
    ds_read_b64_tr_b16 a[150:151], v41 offset:57344
    ds_read_b64_tr_b16 a[152:153], v42 offset:49152
    ds_read_b64_tr_b16 a[154:155], v42 offset:57344
    ds_read_b64_tr_b16 a[156:157], v43 offset:49152
    ds_read_b64_tr_b16 a[158:159], v43 offset:57344
    buffer_load_dwordx4 v18, s[12:15], s4 offen offset:2048 lds
    ds_read_b64_tr_b16 a[160:161], v40 offset:34816
    ds_read_b64_tr_b16 a[162:163], v40 offset:43008
    ds_read_b64_tr_b16 a[164:165], v41 offset:34816
    ds_read_b64_tr_b16 a[166:167], v41 offset:43008
    ds_read_b64_tr_b16 a[168:169], v42 offset:34816
    ds_read_b64_tr_b16 a[170:171], v42 offset:43008
    ds_read_b64_tr_b16 a[172:173], v43 offset:34816
    ds_read_b64_tr_b16 a[174:175], v43 offset:43008
    buffer_load_dwordx4 v19, s[12:15], s4 offen offset:3072 lds
    ds_read_b64_tr_b16 a[176:177], v40 offset:51200
    ds_read_b64_tr_b16 a[178:179], v40 offset:59392
    ds_read_b64_tr_b16 a[180:181], v41 offset:51200
    ds_read_b64_tr_b16 a[182:183], v41 offset:59392
    ds_read_b64_tr_b16 a[184:185], v42 offset:51200
    ds_read_b64_tr_b16 a[186:187], v42 offset:59392
    ds_read_b64_tr_b16 a[188:189], v43 offset:51200
    ds_read_b64_tr_b16 a[190:191], v43 offset:59392
    s_add_u32 s4, s99, 7
    s_and_b32 s4, s4, 7
    s_lshl_b32 s4, s4, 18
    s_add_u32 s4, s4, s22
    s_add_u32 s4, s4, 2097152
    s_add_u32 m0, s23, 102400
    s_nop 0
    buffer_load_dwordx4 v16, s[12:15], s4 offen offset:0 lds
    ds_read_b64_tr_b16 a[192:193], v40 offset:36864
    ds_read_b64_tr_b16 a[194:195], v40 offset:45056
    ds_read_b64_tr_b16 a[196:197], v41 offset:36864
    ds_read_b64_tr_b16 a[198:199], v41 offset:45056
    ds_read_b64_tr_b16 a[200:201], v42 offset:36864
    ds_read_b64_tr_b16 a[202:203], v42 offset:45056
    ds_read_b64_tr_b16 a[204:205], v43 offset:36864
    ds_read_b64_tr_b16 a[206:207], v43 offset:45056
    buffer_load_dwordx4 v17, s[12:15], s4 offen offset:1024 lds
    ds_read_b64_tr_b16 a[208:209], v40 offset:53248
    ds_read_b64_tr_b16 a[210:211], v40 offset:61440
    ds_read_b64_tr_b16 a[212:213], v41 offset:53248
    ds_read_b64_tr_b16 a[214:215], v41 offset:61440
    ds_read_b64_tr_b16 a[216:217], v42 offset:53248
    ds_read_b64_tr_b16 a[218:219], v42 offset:61440
    ds_read_b64_tr_b16 a[220:221], v43 offset:53248
    ds_read_b64_tr_b16 a[222:223], v43 offset:61440
    s_mov_b64 exec, 0xffff
    buffer_load_dwordx2 v[58:59], v53, s[24:27], s57 offen offset:0 sc1
    s_mov_b64 exec, -1
    buffer_load_dwordx4 v18, s[12:15], s4 offen offset:2048 lds
    ds_read_b64_tr_b16 a[224:225], v40 offset:38912
    ds_read_b64_tr_b16 a[226:227], v40 offset:47104
    ds_read_b64_tr_b16 a[228:229], v41 offset:38912
    ds_read_b64_tr_b16 a[230:231], v41 offset:47104
    ds_read_b64_tr_b16 a[232:233], v42 offset:38912
    ds_read_b64_tr_b16 a[234:235], v42 offset:47104
    ds_read_b64_tr_b16 a[236:237], v43 offset:38912
    ds_read_b64_tr_b16 a[238:239], v43 offset:47104
    buffer_load_dwordx4 v19, s[12:15], s4 offen offset:3072 lds
    ds_read_b64_tr_b16 a[240:241], v40 offset:55296
    ds_read_b64_tr_b16 a[242:243], v40 offset:63488
    ds_read_b64_tr_b16 a[244:245], v41 offset:55296
    ds_read_b64_tr_b16 a[246:247], v41 offset:63488
    ds_read_b64_tr_b16 a[248:249], v42 offset:55296
    ds_read_b64_tr_b16 a[250:251], v42 offset:63488
    ds_read_b64_tr_b16 a[252:253], v43 offset:55296
    ds_read_b64_tr_b16 a[254:255], v43 offset:63488
    s_waitcnt lgkmcnt(0)
    s_barrier
    s_add_u32 s4, s100, 1
    s_and_b32 s4, s4, 7
    s_lshl_b32 s4, s4, 18
    s_add_u32 s4, s4, s22
    s_add_u32 s4, s4, 4194304
    s_add_u32 m0, s23, 4096
    s_nop 0
    buffer_load_dwordx4 v16, s[12:15], s4 offen offset:0 lds
    buffer_load_dwordx4 v17, s[12:15], s4 offen offset:1024 lds
    buffer_load_dwordx4 v18, s[12:15], s4 offen offset:2048 lds
    s_mov_b32 s35, 0
    s_mov_b64 exec, 0xffff
    s_waitcnt vmcnt(5)
L_poll_13:
    v_cmp_ne_u64 vcc, s[32:33], v[58:59]
    s_cbranch_vccz L_poll_13_ok
    buffer_load_dwordx2 v[58:59], v53, s[24:27], s57 offen offset:0 sc1
    s_add_u32 s35, s35, 1
    s_waitcnt vmcnt(0)
    s_cmp_lt_u32 s35, 8388608
    s_cbranch_scc1 L_poll_13
L_poll_13_ok:
    s_mov_b64 exec, -1
    s_add_u32 s58, s58, 0x200000
    buffer_load_dwordx4 v[172:175], v52, s[24:27], s36 offen offset:0 sc1
    buffer_load_dwordx4 v[176:179], v52, s[24:27], s36 offen offset:1024 sc1
    buffer_load_dwordx4 v[180:183], v52, s[24:27], s36 offen offset:2048 sc1
    buffer_load_dwordx4 v[184:187], v52, s[24:27], s36 offen offset:3072 sc1
    buffer_load_dwordx4 v[188:191], v52, s[24:27], s38 offen offset:0 sc1
    buffer_load_dwordx4 v[192:195], v52, s[24:27], s38 offen offset:1024 sc1
    buffer_load_dwordx4 v[196:199], v52, s[24:27], s38 offen offset:2048 sc1
    buffer_load_dwordx4 v[200:203], v52, s[24:27], s38 offen offset:3072 sc1
    s_waitcnt vmcnt(7) lgkmcnt(0)
    v_mfma_f32_16x16x32_bf16 v[68:71], a[0:3], v[172:175], v[132:135]
    v_mfma_f32_16x16x32_bf16 v[72:75], a[4:7], v[172:175], v[136:139]
    buffer_load_dwordx4 v[204:207], v52, s[24:27], s39 offen offset:0 sc1
    v_mfma_f32_16x16x32_bf16 v[76:79], a[8:11], v[172:175], v[140:143]
    v_mfma_f32_16x16x32_bf16 v[80:83], a[12:15], v[172:175], v[144:147]
    s_waitcnt vmcnt(7)
    v_mfma_f32_16x16x32_bf16 v[68:71], a[16:19], v[176:179], v[68:71]
    v_mfma_f32_16x16x32_bf16 v[72:75], a[20:23], v[176:179], v[72:75]
    buffer_load_dwordx4 v[208:211], v52, s[24:27], s39 offen offset:1024 sc1
    v_mfma_f32_16x16x32_bf16 v[76:79], a[24:27], v[176:179], v[76:79]
    v_mfma_f32_16x16x32_bf16 v[80:83], a[28:31], v[176:179], v[80:83]
    s_waitcnt vmcnt(7)
    v_mfma_f32_16x16x32_bf16 v[68:71], a[32:35], v[180:183], v[68:71]
    v_mfma_f32_16x16x32_bf16 v[72:75], a[36:39], v[180:183], v[72:75]
    buffer_load_dwordx4 v[212:215], v52, s[24:27], s39 offen offset:2048 sc1
    v_mfma_f32_16x16x32_bf16 v[76:79], a[40:43], v[180:183], v[76:79]
    v_mfma_f32_16x16x32_bf16 v[80:83], a[44:47], v[180:183], v[80:83]
    s_waitcnt vmcnt(7)
    v_mfma_f32_16x16x32_bf16 v[68:71], a[48:51], v[184:187], v[68:71]
    v_mfma_f32_16x16x32_bf16 v[72:75], a[52:55], v[184:187], v[72:75]
    buffer_load_dwordx4 v[216:219], v52, s[24:27], s39 offen offset:3072 sc1
    v_mfma_f32_16x16x32_bf16 v[76:79], a[56:59], v[184:187], v[76:79]
    v_mfma_f32_16x16x32_bf16 v[80:83], a[60:63], v[184:187], v[80:83]
    s_waitcnt vmcnt(7)
    s_barrier
    v_mfma_f32_16x16x32_bf16 v[68:71], a[64:67], v[188:191], v[68:71]
    ds_read_b64_tr_b16 a[0:1], v44 offset:0
    ds_read_b64_tr_b16 a[2:3], v44 offset:8192
    v_mfma_f32_16x16x32_bf16 v[72:75], a[68:71], v[188:191], v[72:75]
    buffer_load_dwordx4 v[220:223], v52, s[24:27], s52 offen offset:0 sc1
    v_mfma_f32_16x16x32_bf16 v[76:79], a[72:75], v[188:191], v[76:79]
    ds_read_b64_tr_b16 a[4:5], v45 offset:0
    ds_read_b64_tr_b16 a[6:7], v45 offset:8192
    v_mfma_f32_16x16x32_bf16 v[80:83], a[76:79], v[188:191], v[80:83]
    ds_read_b64_tr_b16 a[8:9], v46 offset:0
    s_waitcnt vmcnt(7)
    v_mfma_f32_16x16x32_bf16 v[68:71], a[80:83], v[192:195], v[68:71]
    ds_read_b64_tr_b16 a[10:11], v46 offset:8192
    ds_read_b64_tr_b16 a[12:13], v47 offset:0
    v_mfma_f32_16x16x32_bf16 v[72:75], a[84:87], v[192:195], v[72:75]
    buffer_load_dwordx4 v[224:227], v52, s[24:27], s52 offen offset:1024 sc1
    v_mfma_f32_16x16x32_bf16 v[76:79], a[88:91], v[192:195], v[76:79]
    ds_read_b64_tr_b16 a[14:15], v47 offset:8192
    ds_read_b64_tr_b16 a[16:17], v44 offset:16384
    v_mfma_f32_16x16x32_bf16 v[80:83], a[92:95], v[192:195], v[80:83]
    ds_read_b64_tr_b16 a[18:19], v44 offset:24576
    s_waitcnt vmcnt(7)
    v_mfma_f32_16x16x32_bf16 v[68:71], a[96:99], v[196:199], v[68:71]
    ds_read_b64_tr_b16 a[20:21], v45 offset:16384
    ds_read_b64_tr_b16 a[22:23], v45 offset:24576
    v_mfma_f32_16x16x32_bf16 v[72:75], a[100:103], v[196:199], v[72:75]
    buffer_load_dwordx4 v[228:231], v52, s[24:27], s52 offen offset:2048 sc1
    v_mfma_f32_16x16x32_bf16 v[76:79], a[104:107], v[196:199], v[76:79]
    ds_read_b64_tr_b16 a[24:25], v46 offset:16384
    ds_read_b64_tr_b16 a[26:27], v46 offset:24576
    v_mfma_f32_16x16x32_bf16 v[80:83], a[108:111], v[196:199], v[80:83]
    ds_read_b64_tr_b16 a[28:29], v47 offset:16384
    s_waitcnt vmcnt(7)
    v_mfma_f32_16x16x32_bf16 v[68:71], a[112:115], v[200:203], v[68:71]
    ds_read_b64_tr_b16 a[30:31], v47 offset:24576
    ds_read_b64_tr_b16 a[32:33], v44 offset:2048
    v_mfma_f32_16x16x32_bf16 v[72:75], a[116:119], v[200:203], v[72:75]
    buffer_load_dwordx4 v[232:235], v52, s[24:27], s52 offen offset:3072 sc1
    v_mfma_f32_16x16x32_bf16 v[76:79], a[120:123], v[200:203], v[76:79]
    ds_read_b64_tr_b16 a[34:35], v44 offset:10240
    ds_read_b64_tr_b16 a[36:37], v45 offset:2048
    v_mfma_f32_16x16x32_bf16 v[80:83], a[124:127], v[200:203], v[80:83]
    ds_read_b64_tr_b16 a[38:39], v45 offset:10240
    s_waitcnt vmcnt(7)
    v_mfma_f32_16x16x32_bf16 v[68:71], a[128:131], v[204:207], v[68:71]
    ds_read_b64_tr_b16 a[40:41], v46 offset:2048
    ds_read_b64_tr_b16 a[42:43], v46 offset:10240
    v_mfma_f32_16x16x32_bf16 v[72:75], a[132:135], v[204:207], v[72:75]
    buffer_load_dwordx4 v[172:175], v52, s[24:27], s53 offen offset:0 sc1
    v_mfma_f32_16x16x32_bf16 v[76:79], a[136:139], v[204:207], v[76:79]
    ds_read_b64_tr_b16 a[44:45], v47 offset:2048
    ds_read_b64_tr_b16 a[46:47], v47 offset:10240
    v_mfma_f32_16x16x32_bf16 v[80:83], a[140:143], v[204:207], v[80:83]
    ds_read_b64_tr_b16 a[48:49], v44 offset:18432
    s_waitcnt vmcnt(7)
    v_mfma_f32_16x16x32_bf16 v[68:71], a[144:147], v[208:211], v[68:71]
    ds_read_b64_tr_b16 a[50:51], v44 offset:26624
    ds_read_b64_tr_b16 a[52:53], v45 offset:18432
    v_mfma_f32_16x16x32_bf16 v[72:75], a[148:151], v[208:211], v[72:75]
    buffer_load_dwordx4 v[176:179], v52, s[24:27], s53 offen offset:1024 sc1
    v_mfma_f32_16x16x32_bf16 v[76:79], a[152:155], v[208:211], v[76:79]
    ds_read_b64_tr_b16 a[54:55], v45 offset:26624
    ds_read_b64_tr_b16 a[56:57], v46 offset:18432
    v_mfma_f32_16x16x32_bf16 v[80:83], a[156:159], v[208:211], v[80:83]
    ds_read_b64_tr_b16 a[58:59], v46 offset:26624
    s_waitcnt vmcnt(7)
    v_mfma_f32_16x16x32_bf16 v[68:71], a[160:163], v[212:215], v[68:71]
    ds_read_b64_tr_b16 a[60:61], v47 offset:18432
    ds_read_b64_tr_b16 a[62:63], v47 offset:26624
    v_mfma_f32_16x16x32_bf16 v[72:75], a[164:167], v[212:215], v[72:75]
    buffer_load_dwordx4 v[180:183], v52, s[24:27], s53 offen offset:2048 sc1
    v_mfma_f32_16x16x32_bf16 v[76:79], a[168:171], v[212:215], v[76:79]
    ds_read_b64_tr_b16 a[64:65], v44 offset:4096
    ds_read_b64_tr_b16 a[66:67], v44 offset:12288
    v_mfma_f32_16x16x32_bf16 v[80:83], a[172:175], v[212:215], v[80:83]
    ds_read_b64_tr_b16 a[68:69], v45 offset:4096
    s_waitcnt vmcnt(7)
    v_mfma_f32_16x16x32_bf16 v[68:71], a[176:179], v[216:219], v[68:71]
    ds_read_b64_tr_b16 a[70:71], v45 offset:12288
    ds_read_b64_tr_b16 a[72:73], v46 offset:4096
    v_mfma_f32_16x16x32_bf16 v[72:75], a[180:183], v[216:219], v[72:75]
    buffer_load_dwordx4 v[184:187], v52, s[24:27], s53 offen offset:3072 sc1
    v_mfma_f32_16x16x32_bf16 v[76:79], a[184:187], v[216:219], v[76:79]
    ds_read_b64_tr_b16 a[74:75], v46 offset:12288
    ds_read_b64_tr_b16 a[76:77], v47 offset:4096
    v_mfma_f32_16x16x32_bf16 v[80:83], a[188:191], v[216:219], v[80:83]
    ds_read_b64_tr_b16 a[78:79], v47 offset:12288
    s_waitcnt vmcnt(7)
    v_mfma_f32_16x16x32_bf16 v[68:71], a[192:195], v[220:223], v[68:71]
    ds_read_b64_tr_b16 a[80:81], v44 offset:20480
    ds_read_b64_tr_b16 a[82:83], v44 offset:28672
    v_mfma_f32_16x16x32_bf16 v[72:75], a[196:199], v[220:223], v[72:75]
    buffer_load_dwordx4 v[188:191], v52, s[24:27], s54 offen offset:0 sc1
    v_mfma_f32_16x16x32_bf16 v[76:79], a[200:203], v[220:223], v[76:79]
    ds_read_b64_tr_b16 a[84:85], v45 offset:20480
    ds_read_b64_tr_b16 a[86:87], v45 offset:28672
    v_mfma_f32_16x16x32_bf16 v[80:83], a[204:207], v[220:223], v[80:83]
    ds_read_b64_tr_b16 a[88:89], v46 offset:20480
    s_waitcnt vmcnt(7)
    v_mfma_f32_16x16x32_bf16 v[68:71], a[208:211], v[224:227], v[68:71]
    ds_read_b64_tr_b16 a[90:91], v46 offset:28672
    ds_read_b64_tr_b16 a[92:93], v47 offset:20480
    v_mfma_f32_16x16x32_bf16 v[72:75], a[212:215], v[224:227], v[72:75]
    buffer_load_dwordx4 v[192:195], v52, s[24:27], s54 offen offset:1024 sc1
    v_mfma_f32_16x16x32_bf16 v[76:79], a[216:219], v[224:227], v[76:79]
    ds_read_b64_tr_b16 a[94:95], v47 offset:28672
    ds_read_b64_tr_b16 a[96:97], v44 offset:6144
    v_mfma_f32_16x16x32_bf16 v[80:83], a[220:223], v[224:227], v[80:83]
    ds_read_b64_tr_b16 a[98:99], v44 offset:14336
    s_waitcnt vmcnt(7)
    v_mfma_f32_16x16x32_bf16 v[68:71], a[224:227], v[228:231], v[68:71]
    ds_read_b64_tr_b16 a[100:101], v45 offset:6144
    ds_read_b64_tr_b16 a[102:103], v45 offset:14336
    v_mfma_f32_16x16x32_bf16 v[72:75], a[228:231], v[228:231], v[72:75]
    buffer_load_dwordx4 v[196:199], v52, s[24:27], s54 offen offset:2048 sc1
    v_mfma_f32_16x16x32_bf16 v[76:79], a[232:235], v[228:231], v[76:79]
    ds_read_b64_tr_b16 a[104:105], v46 offset:6144
    ds_read_b64_tr_b16 a[106:107], v46 offset:14336
    v_mfma_f32_16x16x32_bf16 v[80:83], a[236:239], v[228:231], v[80:83]
    ds_read_b64_tr_b16 a[108:109], v47 offset:6144
    s_waitcnt vmcnt(7)
    v_mfma_f32_16x16x32_bf16 v[68:71], a[240:243], v[232:235], v[68:71]
    ds_read_b64_tr_b16 a[110:111], v47 offset:14336
    ds_read_b64_tr_b16 a[112:113], v44 offset:22528
    v_mfma_f32_16x16x32_bf16 v[72:75], a[244:247], v[232:235], v[72:75]
    buffer_load_dwordx4 v[200:203], v52, s[24:27], s54 offen offset:3072 sc1
    v_mfma_f32_16x16x32_bf16 v[76:79], a[248:251], v[232:235], v[76:79]
    ds_read_b64_tr_b16 a[114:115], v44 offset:30720
    ds_read_b64_tr_b16 a[116:117], v45 offset:22528
    v_mfma_f32_16x16x32_bf16 v[80:83], a[252:255], v[232:235], v[80:83]
    ds_read_b64_tr_b16 a[118:119], v45 offset:30720
    s_waitcnt vmcnt(7)
    v_mfma_f32_16x16x32_bf16 v[68:71], a[0:3], v[172:175], v[68:71]
    ds_read_b64_tr_b16 a[120:121], v46 offset:22528
    ds_read_b64_tr_b16 a[122:123], v46 offset:30720
    v_mfma_f32_16x16x32_bf16 v[72:75], a[4:7], v[172:175], v[72:75]
    buffer_load_dwordx4 v[204:207], v52, s[24:27], s55 offen offset:0 sc1
    v_mfma_f32_16x16x32_bf16 v[76:79], a[8:11], v[172:175], v[76:79]
    ds_read_b64_tr_b16 a[124:125], v47 offset:22528
    ds_read_b64_tr_b16 a[126:127], v47 offset:30720
    v_mfma_f32_16x16x32_bf16 v[80:83], a[12:15], v[172:175], v[80:83]
    ds_read_b64_tr_b16 a[128:129], v44 offset:32768
    s_waitcnt vmcnt(7)
    v_mfma_f32_16x16x32_bf16 v[68:71], a[16:19], v[176:179], v[68:71]
    ds_read_b64_tr_b16 a[130:131], v44 offset:40960
    ds_read_b64_tr_b16 a[132:133], v45 offset:32768
    v_mfma_f32_16x16x32_bf16 v[72:75], a[20:23], v[176:179], v[72:75]
    buffer_load_dwordx4 v[208:211], v52, s[24:27], s55 offen offset:1024 sc1
    v_mfma_f32_16x16x32_bf16 v[76:79], a[24:27], v[176:179], v[76:79]
    ds_read_b64_tr_b16 a[134:135], v45 offset:40960
    ds_read_b64_tr_b16 a[136:137], v46 offset:32768
    v_mfma_f32_16x16x32_bf16 v[80:83], a[28:31], v[176:179], v[80:83]
    ds_read_b64_tr_b16 a[138:139], v46 offset:40960
    s_waitcnt vmcnt(7)
    v_mfma_f32_16x16x32_bf16 v[68:71], a[32:35], v[180:183], v[68:71]
    ds_read_b64_tr_b16 a[140:141], v47 offset:32768
    ds_read_b64_tr_b16 a[142:143], v47 offset:40960
    v_mfma_f32_16x16x32_bf16 v[72:75], a[36:39], v[180:183], v[72:75]
    buffer_load_dwordx4 v[212:215], v52, s[24:27], s55 offen offset:2048 sc1
    v_mfma_f32_16x16x32_bf16 v[76:79], a[40:43], v[180:183], v[76:79]
    ds_read_b64_tr_b16 a[144:145], v44 offset:49152
    ds_read_b64_tr_b16 a[146:147], v44 offset:57344
    v_mfma_f32_16x16x32_bf16 v[80:83], a[44:47], v[180:183], v[80:83]
    ds_read_b64_tr_b16 a[148:149], v45 offset:49152
    s_waitcnt vmcnt(7)
    v_mfma_f32_16x16x32_bf16 v[68:71], a[48:51], v[184:187], v[68:71]
    ds_read_b64_tr_b16 a[150:151], v45 offset:57344
    ds_read_b64_tr_b16 a[152:153], v46 offset:49152
    v_mfma_f32_16x16x32_bf16 v[72:75], a[52:55], v[184:187], v[72:75]
    buffer_load_dwordx4 v[216:219], v52, s[24:27], s55 offen offset:3072 sc1
    v_mfma_f32_16x16x32_bf16 v[76:79], a[56:59], v[184:187], v[76:79]
    ds_read_b64_tr_b16 a[154:155], v46 offset:57344
    ds_read_b64_tr_b16 a[156:157], v47 offset:49152
    v_mfma_f32_16x16x32_bf16 v[80:83], a[60:63], v[184:187], v[80:83]
    ds_read_b64_tr_b16 a[158:159], v47 offset:57344
    s_waitcnt vmcnt(7)
    v_mfma_f32_16x16x32_bf16 v[68:71], a[64:67], v[188:191], v[68:71]
    ds_read_b64_tr_b16 a[160:161], v44 offset:34816
    ds_read_b64_tr_b16 a[162:163], v44 offset:43008
    v_mfma_f32_16x16x32_bf16 v[72:75], a[68:71], v[188:191], v[72:75]
    buffer_load_dwordx4 v[220:223], v52, s[24:27], s101 offen offset:0 sc1
    v_mfma_f32_16x16x32_bf16 v[76:79], a[72:75], v[188:191], v[76:79]
    ds_read_b64_tr_b16 a[164:165], v45 offset:34816
    ds_read_b64_tr_b16 a[166:167], v45 offset:43008
    v_mfma_f32_16x16x32_bf16 v[80:83], a[76:79], v[188:191], v[80:83]
    ds_read_b64_tr_b16 a[168:169], v46 offset:34816
    s_waitcnt vmcnt(7)
    v_mfma_f32_16x16x32_bf16 v[68:71], a[80:83], v[192:195], v[68:71]
    ds_read_b64_tr_b16 a[170:171], v46 offset:43008
    ds_read_b64_tr_b16 a[172:173], v47 offset:34816
    v_mfma_f32_16x16x32_bf16 v[72:75], a[84:87], v[192:195], v[72:75]
    buffer_load_dwordx4 v[224:227], v52, s[24:27], s101 offen offset:1024 sc1
    v_mfma_f32_16x16x32_bf16 v[76:79], a[88:91], v[192:195], v[76:79]
    ds_read_b64_tr_b16 a[174:175], v47 offset:43008
    ds_read_b64_tr_b16 a[176:177], v44 offset:51200
    v_mfma_f32_16x16x32_bf16 v[80:83], a[92:95], v[192:195], v[80:83]
    ds_read_b64_tr_b16 a[178:179], v44 offset:59392
    s_waitcnt vmcnt(7)
    v_mfma_f32_16x16x32_bf16 v[68:71], a[96:99], v[196:199], v[68:71]
    ds_read_b64_tr_b16 a[180:181], v45 offset:51200
    ds_read_b64_tr_b16 a[182:183], v45 offset:59392
    v_mfma_f32_16x16x32_bf16 v[72:75], a[100:103], v[196:199], v[72:75]
    buffer_load_dwordx4 v[228:231], v52, s[24:27], s101 offen offset:2048 sc1
    v_mfma_f32_16x16x32_bf16 v[76:79], a[104:107], v[196:199], v[76:79]
    ds_read_b64_tr_b16 a[184:185], v46 offset:51200
    ds_read_b64_tr_b16 a[186:187], v46 offset:59392
    v_mfma_f32_16x16x32_bf16 v[80:83], a[108:111], v[196:199], v[80:83]
    ds_read_b64_tr_b16 a[188:189], v47 offset:51200
    s_waitcnt vmcnt(7)
    v_mfma_f32_16x16x32_bf16 v[68:71], a[112:115], v[200:203], v[68:71]
    ds_read_b64_tr_b16 a[190:191], v47 offset:59392
    ds_read_b64_tr_b16 a[192:193], v44 offset:36864
    v_mfma_f32_16x16x32_bf16 v[72:75], a[116:119], v[200:203], v[72:75]
    buffer_load_dwordx4 v[232:235], v52, s[24:27], s101 offen offset:3072 sc1
    v_mfma_f32_16x16x32_bf16 v[76:79], a[120:123], v[200:203], v[76:79]
    ds_read_b64_tr_b16 a[194:195], v44 offset:45056
    ds_read_b64_tr_b16 a[196:197], v45 offset:36864
    v_mfma_f32_16x16x32_bf16 v[80:83], a[124:127], v[200:203], v[80:83]
    ds_read_b64_tr_b16 a[198:199], v45 offset:45056
    s_waitcnt vmcnt(7)
    v_mfma_f32_16x16x32_bf16 v[68:71], a[128:131], v[204:207], v[68:71]
    ds_read_b64_tr_b16 a[200:201], v46 offset:36864
    ds_read_b64_tr_b16 a[202:203], v46 offset:45056
    v_mfma_f32_16x16x32_bf16 v[72:75], a[132:135], v[204:207], v[72:75]
    v_mfma_f32_16x16x32_bf16 v[76:79], a[136:139], v[204:207], v[76:79]
    ds_read_b64_tr_b16 a[204:205], v47 offset:36864
    ds_read_b64_tr_b16 a[206:207], v47 offset:45056
    v_mfma_f32_16x16x32_bf16 v[80:83], a[140:143], v[204:207], v[80:83]
    ds_read_b64_tr_b16 a[208:209], v44 offset:53248
    buffer_load_dwordx4 v19, s[12:15], s4 offen offset:3072 lds
    s_waitcnt vmcnt(7)
    v_mfma_f32_16x16x32_bf16 v[68:71], a[144:147], v[208:211], v[68:71]
    ds_read_b64_tr_b16 a[210:211], v44 offset:61440
    ds_read_b64_tr_b16 a[212:213], v45 offset:53248
    v_mfma_f32_16x16x32_bf16 v[72:75], a[148:151], v[208:211], v[72:75]
    v_mfma_f32_16x16x32_bf16 v[76:79], a[152:155], v[208:211], v[76:79]
    ds_read_b64_tr_b16 a[214:215], v45 offset:61440
    ds_read_b64_tr_b16 a[216:217], v46 offset:53248
    v_mfma_f32_16x16x32_bf16 v[80:83], a[156:159], v[208:211], v[80:83]
    ds_read_b64_tr_b16 a[218:219], v46 offset:61440
    s_add_u32 s4, s100, 2
    s_and_b32 s4, s4, 7
    s_lshl_b32 s4, s4, 18
    s_add_u32 s4, s4, s22
    s_add_u32 s4, s4, 4194304
    s_add_u32 m0, s23, 32768
    s_nop 0
    buffer_load_dwordx4 v16, s[12:15], s4 offen offset:0 lds
    s_waitcnt vmcnt(7)
    v_mfma_f32_16x16x32_bf16 v[68:71], a[160:163], v[212:215], v[68:71]
    ds_read_b64_tr_b16 a[220:221], v47 offset:53248
    ds_read_b64_tr_b16 a[222:223], v47 offset:61440
    v_mfma_f32_16x16x32_bf16 v[72:75], a[164:167], v[212:215], v[72:75]
    v_mfma_f32_16x16x32_bf16 v[76:79], a[168:171], v[212:215], v[76:79]
    ds_read_b64_tr_b16 a[224:225], v44 offset:38912
    ds_read_b64_tr_b16 a[226:227], v44 offset:47104
    v_mfma_f32_16x16x32_bf16 v[80:83], a[172:175], v[212:215], v[80:83]
    ds_read_b64_tr_b16 a[228:229], v45 offset:38912
    buffer_load_dwordx4 v17, s[12:15], s4 offen offset:1024 lds
    s_waitcnt vmcnt(7)
    v_mfma_f32_16x16x32_bf16 v[68:71], a[176:179], v[216:219], v[68:71]
    ds_read_b64_tr_b16 a[230:231], v45 offset:47104
    ds_read_b64_tr_b16 a[232:233], v46 offset:38912
    v_mfma_f32_16x16x32_bf16 v[72:75], a[180:183], v[216:219], v[72:75]
    v_mfma_f32_16x16x32_bf16 v[76:79], a[184:187], v[216:219], v[76:79]
    ds_read_b64_tr_b16 a[234:235], v46 offset:47104
    ds_read_b64_tr_b16 a[236:237], v47 offset:38912
    v_mfma_f32_16x16x32_bf16 v[80:83], a[188:191], v[216:219], v[80:83]
    ds_read_b64_tr_b16 a[238:239], v47 offset:47104
    buffer_load_dwordx4 v18, s[12:15], s4 offen offset:2048 lds
    s_waitcnt vmcnt(7)
    v_mfma_f32_16x16x32_bf16 v[68:71], a[192:195], v[220:223], v[68:71]
    ds_read_b64_tr_b16 a[240:241], v44 offset:55296
    ds_read_b64_tr_b16 a[242:243], v44 offset:63488
    v_mfma_f32_16x16x32_bf16 v[72:75], a[196:199], v[220:223], v[72:75]
    v_mfma_f32_16x16x32_bf16 v[76:79], a[200:203], v[220:223], v[76:79]
    ds_read_b64_tr_b16 a[244:245], v45 offset:55296
    ds_read_b64_tr_b16 a[246:247], v45 offset:63488
    v_mfma_f32_16x16x32_bf16 v[80:83], a[204:207], v[220:223], v[80:83]
    ds_read_b64_tr_b16 a[248:249], v46 offset:55296
    buffer_load_dwordx4 v19, s[12:15], s4 offen offset:3072 lds
    s_waitcnt vmcnt(7) lgkmcnt(13)
    v_mfma_f32_16x16x32_bf16 v[68:71], a[208:211], v[224:227], v[68:71]
    ds_read_b64_tr_b16 a[250:251], v46 offset:63488
    ds_read_b64_tr_b16 a[252:253], v47 offset:55296
    v_mfma_f32_16x16x32_bf16 v[72:75], a[212:215], v[224:227], v[72:75]
    v_mfma_f32_16x16x32_bf16 v[76:79], a[216:219], v[224:227], v[76:79]
    ds_read_b64_tr_b16 a[254:255], v47 offset:63488
    v_mfma_f32_16x16x32_bf16 v[80:83], a[220:223], v[224:227], v[80:83]
    s_add_u32 s4, s100, 3
    s_and_b32 s4, s4, 7
    s_lshl_b32 s4, s4, 18
    s_add_u32 s4, s4, s22
    s_add_u32 s4, s4, 4194304
    s_add_u32 m0, s23, 36864
    s_nop 0
    buffer_load_dwordx4 v16, s[12:15], s4 offen offset:0 lds
    s_waitcnt vmcnt(7) lgkmcnt(8)
    v_mfma_f32_16x16x32_bf16 v[68:71], a[224:227], v[228:231], v[68:71]
    v_mfma_f32_16x16x32_bf16 v[72:75], a[228:231], v[228:231], v[72:75]
    v_mfma_f32_16x16x32_bf16 v[76:79], a[232:235], v[228:231], v[76:79]
    v_mfma_f32_16x16x32_bf16 v[80:83], a[236:239], v[228:231], v[80:83]
    buffer_load_dwordx4 v17, s[12:15], s4 offen offset:1024 lds
    s_waitcnt vmcnt(7) lgkmcnt(0)
    v_mfma_f32_16x16x32_bf16 v[68:71], a[240:243], v[232:235], v[68:71]
    v_mfma_f32_16x16x32_bf16 v[72:75], a[244:247], v[232:235], v[72:75]
    v_mfma_f32_16x16x32_bf16 v[76:79], a[248:251], v[232:235], v[76:79]
    v_mfma_f32_16x16x32_bf16 v[80:83], a[252:255], v[232:235], v[80:83]
    s_nop 0
    s_nop 4
    v_pk_fma_f32 v[68:69], v[68:69], v[84:85], v[100:101]
    v_pk_fma_f32 v[70:71], v[70:71], v[86:87], v[102:103]
    v_cvt_pk_bf16_f32 v164, v68, v69
    v_cvt_pk_bf16_f32 v165, v70, v71
    v_pk_fma_f32 v[72:73], v[72:73], v[88:89], v[104:105]
    v_pk_fma_f32 v[74:75], v[74:75], v[90:91], v[106:107]
    v_cvt_pk_bf16_f32 v166, v72, v73
    v_cvt_pk_bf16_f32 v167, v74, v75
    buffer_store_dwordx4 v[164:167], v52, s[24:27], s58 offen offset:0 sc1
    v_pk_fma_f32 v[76:77], v[76:77], v[92:93], v[108:109]
    v_pk_fma_f32 v[78:79], v[78:79], v[94:95], v[110:111]
    v_cvt_pk_bf16_f32 v168, v76, v77
    v_cvt_pk_bf16_f32 v169, v78, v79
    v_pk_fma_f32 v[80:81], v[80:81], v[96:97], v[112:113]
    v_pk_fma_f32 v[82:83], v[82:83], v[98:99], v[114:115]
    v_cvt_pk_bf16_f32 v170, v80, v81
    v_cvt_pk_bf16_f32 v171, v82, v83
    buffer_store_dwordx4 v[168:171], v52, s[24:27], s58 offen offset:1024 sc1
    s_barrier
    buffer_load_dwordx4 v18, s[12:15], s4 offen offset:2048 lds
    v_lshlrev_b32 v100, 16, v164
    v_and_b32 v101, 0xffff0000, v164
    v_lshlrev_b32 v102, 16, v165
    v_and_b32 v103, 0xffff0000, v165
    v_lshlrev_b32 v104, 16, v166
    v_and_b32 v105, 0xffff0000, v166
    v_lshlrev_b32 v106, 16, v167
    v_and_b32 v107, 0xffff0000, v167
    v_lshlrev_b32 v108, 16, v168
    v_and_b32 v109, 0xffff0000, v168
    v_lshlrev_b32 v110, 16, v169
    v_and_b32 v111, 0xffff0000, v169
    v_lshlrev_b32 v112, 16, v170
    v_and_b32 v113, 0xffff0000, v170
    v_lshlrev_b32 v114, 16, v171
    v_and_b32 v115, 0xffff0000, v171
    buffer_load_dwordx4 v19, s[12:15], s4 offen offset:3072 lds
    s_add_u32 s59, s59, 0x200000
    s_add_u32 s36, s100, 0
    s_and_b32 s36, s36, 7
    s_lshl_b32 s36, s36, 12
    s_add_u32 s36, s36, s59
    s_add_u32 s38, s100, 1
    s_and_b32 s38, s38, 7
    s_lshl_b32 s38, s38, 12
    s_add_u32 s38, s38, s59
    s_add_u32 s39, s100, 2
    s_and_b32 s39, s39, 7
    s_lshl_b32 s39, s39, 12
    s_add_u32 s39, s39, s59
    s_add_u32 s52, s100, 3
    s_and_b32 s52, s52, 7
    s_lshl_b32 s52, s52, 12
    s_add_u32 s52, s52, s59
    s_add_u32 s53, s100, 4
    s_and_b32 s53, s53, 7
    s_lshl_b32 s53, s53, 12
    s_add_u32 s53, s53, s59
    s_add_u32 s54, s100, 5
    s_and_b32 s54, s54, 7
    s_lshl_b32 s54, s54, 12
    s_add_u32 s54, s54, s59
    s_add_u32 s55, s100, 6
    s_and_b32 s55, s55, 7
    s_lshl_b32 s55, s55, 12
    s_add_u32 s55, s55, s59
    s_add_u32 s101, s100, 7
    s_and_b32 s101, s101, 7
    s_lshl_b32 s101, s101, 12
    s_add_u32 s101, s101, s59
    s_add_u32 s4, s100, 4
    s_and_b32 s4, s4, 7
    s_lshl_b32 s4, s4, 18
    s_add_u32 s4, s4, s22
    s_add_u32 s4, s4, 4194304
    s_add_u32 m0, s23, 65536
    s_nop 0
    buffer_load_dwordx4 v16, s[12:15], s4 offen offset:0 lds
    buffer_load_dwordx4 v17, s[12:15], s4 offen offset:1024 lds
    buffer_load_dwordx4 v18, s[12:15], s4 offen offset:2048 lds
    buffer_load_dwordx4 v19, s[12:15], s4 offen offset:3072 lds
    s_add_u32 s4, s100, 5
    s_and_b32 s4, s4, 7
    s_lshl_b32 s4, s4, 18
    s_add_u32 s4, s4, s22
    s_add_u32 s4, s4, 4194304
    s_add_u32 m0, s23, 69632
    s_nop 0
    buffer_load_dwordx4 v16, s[12:15], s4 offen offset:0 lds
    buffer_load_dwordx4 v17, s[12:15], s4 offen offset:1024 lds
    s_waitcnt vmcnt(8)
    s_mov_b64 exec, 1
    buffer_store_dwordx2 v[56:57], v54, s[24:27], s56 offen offset:8 sc1
    s_mov_b64 exec, -1
    s_waitcnt vmcnt(7)
    s_barrier
    buffer_load_dwordx4 v18, s[12:15], s4 offen offset:2048 lds
    ds_read_b64_tr_b16 a[0:1], v32 offset:0
    ds_read_b64_tr_b16 a[2:3], v32 offset:4096
    ds_read_b64_tr_b16 a[4:5], v33 offset:0
    ds_read_b64_tr_b16 a[6:7], v33 offset:4096
    ds_read_b64_tr_b16 a[8:9], v34 offset:0
    ds_read_b64_tr_b16 a[10:11], v34 offset:4096
    ds_read_b64_tr_b16 a[12:13], v35 offset:0
    ds_read_b64_tr_b16 a[14:15], v35 offset:4096
    ds_read_b64_tr_b16 a[16:17], v32 offset:8192
    ds_read_b64_tr_b16 a[18:19], v32 offset:12288
    ds_read_b64_tr_b16 a[20:21], v33 offset:8192
    ds_read_b64_tr_b16 a[22:23], v33 offset:12288
    ds_read_b64_tr_b16 a[24:25], v34 offset:8192
    buffer_load_dwordx4 v19, s[12:15], s4 offen offset:3072 lds
    ds_read_b64_tr_b16 a[26:27], v34 offset:12288
    ds_read_b64_tr_b16 a[28:29], v35 offset:8192
    ds_read_b64_tr_b16 a[30:31], v35 offset:12288
    ds_read_b64_tr_b16 a[32:33], v32 offset:2048
    ds_read_b64_tr_b16 a[34:35], v32 offset:6144
    ds_read_b64_tr_b16 a[36:37], v33 offset:2048
    ds_read_b64_tr_b16 a[38:39], v33 offset:6144
    ds_read_b64_tr_b16 a[40:41], v34 offset:2048
    ds_read_b64_tr_b16 a[42:43], v34 offset:6144
    ds_read_b64_tr_b16 a[44:45], v35 offset:2048
    ds_read_b64_tr_b16 a[46:47], v35 offset:6144
    ds_read_b64_tr_b16 a[48:49], v32 offset:10240
    ds_read_b64_tr_b16 a[50:51], v32 offset:14336
    s_add_u32 s4, s100, 6
    s_and_b32 s4, s4, 7
    s_lshl_b32 s4, s4, 18
    s_add_u32 s4, s4, s22
    s_add_u32 s4, s4, 4194304
    s_add_u32 m0, s23, 98304
    s_nop 0
    buffer_load_dwordx4 v16, s[12:15], s4 offen offset:0 lds
    ds_read_b64_tr_b16 a[52:53], v33 offset:10240
    ds_read_b64_tr_b16 a[54:55], v33 offset:14336
    ds_read_b64_tr_b16 a[56:57], v34 offset:10240
    ds_read_b64_tr_b16 a[58:59], v34 offset:14336
    ds_read_b64_tr_b16 a[60:61], v35 offset:10240
    ds_read_b64_tr_b16 a[62:63], v35 offset:14336
    ds_read_b64_tr_b16 a[64:65], v40 offset:4096
    ds_read_b64_tr_b16 a[66:67], v40 offset:12288
    ds_read_b64_tr_b16 a[68:69], v41 offset:4096
    ds_read_b64_tr_b16 a[70:71], v41 offset:12288
    ds_read_b64_tr_b16 a[72:73], v42 offset:4096
    ds_read_b64_tr_b16 a[74:75], v42 offset:12288
    ds_read_b64_tr_b16 a[76:77], v43 offset:4096
    buffer_load_dwordx4 v17, s[12:15], s4 offen offset:1024 lds
    ds_read_b64_tr_b16 a[78:79], v43 offset:12288
    ds_read_b64_tr_b16 a[80:81], v40 offset:20480
    ds_read_b64_tr_b16 a[82:83], v40 offset:28672
    ds_read_b64_tr_b16 a[84:85], v41 offset:20480
    ds_read_b64_tr_b16 a[86:87], v41 offset:28672
    ds_read_b64_tr_b16 a[88:89], v42 offset:20480
    ds_read_b64_tr_b16 a[90:91], v42 offset:28672
    ds_read_b64_tr_b16 a[92:93], v43 offset:20480
    ds_read_b64_tr_b16 a[94:95], v43 offset:28672
    ds_read_b64_tr_b16 a[96:97], v40 offset:6144
    ds_read_b64_tr_b16 a[98:99], v40 offset:14336
    ds_read_b64_tr_b16 a[100:101], v41 offset:6144
    ds_read_b64_tr_b16 a[102:103], v41 offset:14336
    buffer_load_dwordx4 v18, s[12:15], s4 offen offset:2048 lds
    ds_read_b64_tr_b16 a[104:105], v42 offset:6144
    ds_read_b64_tr_b16 a[106:107], v42 offset:14336
    ds_read_b64_tr_b16 a[108:109], v43 offset:6144
    ds_read_b64_tr_b16 a[110:111], v43 offset:14336
    ds_read_b64_tr_b16 a[112:113], v40 offset:22528
    ds_read_b64_tr_b16 a[114:115], v40 offset:30720
    ds_read_b64_tr_b16 a[116:117], v41 offset:22528
    ds_read_b64_tr_b16 a[118:119], v41 offset:30720
    ds_read_b64_tr_b16 a[120:121], v42 offset:22528
    ds_read_b64_tr_b16 a[122:123], v42 offset:30720
    ds_read_b64_tr_b16 a[124:125], v43 offset:22528
    ds_read_b64_tr_b16 a[126:127], v43 offset:30720
    ds_read_b64_tr_b16 a[128:129], v40 offset:32768
    buffer_load_dwordx4 v19, s[12:15], s4 offen offset:3072 lds
    ds_read_b64_tr_b16 a[130:131], v40 offset:40960
    ds_read_b64_tr_b16 a[132:133], v41 offset:32768
    ds_read_b64_tr_b16 a[134:135], v41 offset:40960
    ds_read_b64_tr_b16 a[136:137], v42 offset:32768
    ds_read_b64_tr_b16 a[138:139], v42 offset:40960
    ds_read_b64_tr_b16 a[140:141], v43 offset:32768
    ds_read_b64_tr_b16 a[142:143], v43 offset:40960
    ds_read_b64_tr_b16 a[144:145], v40 offset:49152
    ds_read_b64_tr_b16 a[146:147], v40 offset:57344
    ds_read_b64_tr_b16 a[148:149], v41 offset:49152
    ds_read_b64_tr_b16 a[150:151], v41 offset:57344
    ds_read_b64_tr_b16 a[152:153], v42 offset:49152
    ds_read_b64_tr_b16 a[154:155], v42 offset:57344
    s_add_u32 s4, s100, 7
    s_and_b32 s4, s4, 7
    s_lshl_b32 s4, s4, 18
    s_add_u32 s4, s4, s22
    s_add_u32 s4, s4, 4194304
    s_add_u32 m0, s23, 102400
    s_nop 0
    buffer_load_dwordx4 v16, s[12:15], s4 offen offset:0 lds
    ds_read_b64_tr_b16 a[156:157], v43 offset:49152
    ds_read_b64_tr_b16 a[158:159], v43 offset:57344
    ds_read_b64_tr_b16 a[160:161], v40 offset:34816
    ds_read_b64_tr_b16 a[162:163], v40 offset:43008
    ds_read_b64_tr_b16 a[164:165], v41 offset:34816
    ds_read_b64_tr_b16 a[166:167], v41 offset:43008
    ds_read_b64_tr_b16 a[168:169], v42 offset:34816
    ds_read_b64_tr_b16 a[170:171], v42 offset:43008
    ds_read_b64_tr_b16 a[172:173], v43 offset:34816
    ds_read_b64_tr_b16 a[174:175], v43 offset:43008
    ds_read_b64_tr_b16 a[176:177], v40 offset:51200
    ds_read_b64_tr_b16 a[178:179], v40 offset:59392
    ds_read_b64_tr_b16 a[180:181], v41 offset:51200
    buffer_load_dwordx4 v17, s[12:15], s4 offen offset:1024 lds
    ds_read_b64_tr_b16 a[182:183], v41 offset:59392
    ds_read_b64_tr_b16 a[184:185], v42 offset:51200
    ds_read_b64_tr_b16 a[186:187], v42 offset:59392
    ds_read_b64_tr_b16 a[188:189], v43 offset:51200
    ds_read_b64_tr_b16 a[190:191], v43 offset:59392
    ds_read_b64_tr_b16 a[192:193], v40 offset:36864
    ds_read_b64_tr_b16 a[194:195], v40 offset:45056
    ds_read_b64_tr_b16 a[196:197], v41 offset:36864
    ds_read_b64_tr_b16 a[198:199], v41 offset:45056
    ds_read_b64_tr_b16 a[200:201], v42 offset:36864
    ds_read_b64_tr_b16 a[202:203], v42 offset:45056
    ds_read_b64_tr_b16 a[204:205], v43 offset:36864
    ds_read_b64_tr_b16 a[206:207], v43 offset:45056
    buffer_load_dwordx4 v18, s[12:15], s4 offen offset:2048 lds
    ds_read_b64_tr_b16 a[208:209], v40 offset:53248
    ds_read_b64_tr_b16 a[210:211], v40 offset:61440
    ds_read_b64_tr_b16 a[212:213], v41 offset:53248
    ds_read_b64_tr_b16 a[214:215], v41 offset:61440
    ds_read_b64_tr_b16 a[216:217], v42 offset:53248
    ds_read_b64_tr_b16 a[218:219], v42 offset:61440
    ds_read_b64_tr_b16 a[220:221], v43 offset:53248
    ds_read_b64_tr_b16 a[222:223], v43 offset:61440
    ds_read_b64_tr_b16 a[224:225], v40 offset:38912
    ds_read_b64_tr_b16 a[226:227], v40 offset:47104
    ds_read_b64_tr_b16 a[228:229], v41 offset:38912
    ds_read_b64_tr_b16 a[230:231], v41 offset:47104
    ds_read_b64_tr_b16 a[232:233], v42 offset:38912
    buffer_load_dwordx4 v19, s[12:15], s4 offen offset:3072 lds
    ds_read_b64_tr_b16 a[234:235], v42 offset:47104
    ds_read_b64_tr_b16 a[236:237], v43 offset:38912
    ds_read_b64_tr_b16 a[238:239], v43 offset:47104
    ds_read_b64_tr_b16 a[240:241], v40 offset:55296
    ds_read_b64_tr_b16 a[242:243], v40 offset:63488
    ds_read_b64_tr_b16 a[244:245], v41 offset:55296
    ds_read_b64_tr_b16 a[246:247], v41 offset:63488
    ds_read_b64_tr_b16 a[248:249], v42 offset:55296
    ds_read_b64_tr_b16 a[250:251], v42 offset:63488
    ds_read_b64_tr_b16 a[252:253], v43 offset:55296
    ds_read_b64_tr_b16 a[254:255], v43 offset:63488
    s_mov_b64 exec, 0xffff
    buffer_load_dwordx2 v[58:59], v53, s[24:27], s57 offen offset:8 sc1
    s_mov_b64 exec, -1
    s_mov_b32 s35, 0
    s_mov_b64 exec, 0xffff
    s_waitcnt vmcnt(0)
L_poll_14:
    v_cmp_ne_u64 vcc, s[32:33], v[58:59]
    s_cbranch_vccz L_poll_14_ok
    buffer_load_dwordx2 v[58:59], v53, s[24:27], s57 offen offset:8 sc1
    s_add_u32 s35, s35, 1
    s_waitcnt vmcnt(0)
    s_cmp_lt_u32 s35, 8388608
    s_cbranch_scc1 L_poll_14
L_poll_14_ok:
    s_mov_b64 exec, -1
    v_add_u32 v60, s43, v52
    s_add_u32 s37, s42, 16384
    buffer_load_dwordx4 v[172:175], v52, s[24:27], s36 offen offset:0 sc1
    buffer_load_dwordx4 v[176:179], v52, s[24:27], s36 offen offset:1024 sc1
    buffer_load_dwordx4 v[180:183], v52, s[24:27], s36 offen offset:2048 sc1
    buffer_load_dwordx4 v[184:187], v52, s[24:27], s36 offen offset:3072 sc1
    buffer_load_dwordx4 v[188:191], v52, s[24:27], s38 offen offset:0 sc1
    buffer_load_dwordx4 v[192:195], v52, s[24:27], s38 offen offset:1024 sc1
    buffer_load_dwordx4 v[196:199], v52, s[24:27], s38 offen offset:2048 sc1
    buffer_load_dwordx4 v[200:203], v52, s[24:27], s38 offen offset:3072 sc1
    s_waitcnt vmcnt(7) lgkmcnt(0)
    v_mfma_f32_16x16x32_bf16 v[68:71], a[0:3], v[172:175], v[148:151]
    v_mfma_f32_16x16x32_bf16 v[72:75], a[4:7], v[172:175], v[152:155]
    buffer_load_dwordx4 v[204:207], v52, s[24:27], s39 offen offset:0 sc1
    v_mfma_f32_16x16x32_bf16 v[76:79], a[8:11], v[172:175], v[156:159]
    v_mfma_f32_16x16x32_bf16 v[80:83], a[12:15], v[172:175], v[160:163]
    s_waitcnt vmcnt(7)
    v_mfma_f32_16x16x32_bf16 v[68:71], a[16:19], v[176:179], v[68:71]
    v_mfma_f32_16x16x32_bf16 v[72:75], a[20:23], v[176:179], v[72:75]
    buffer_load_dwordx4 v[208:211], v52, s[24:27], s39 offen offset:1024 sc1
    v_mfma_f32_16x16x32_bf16 v[76:79], a[24:27], v[176:179], v[76:79]
    v_mfma_f32_16x16x32_bf16 v[80:83], a[28:31], v[176:179], v[80:83]
    s_waitcnt vmcnt(7)
    v_mfma_f32_16x16x32_bf16 v[68:71], a[32:35], v[180:183], v[68:71]
    v_mfma_f32_16x16x32_bf16 v[72:75], a[36:39], v[180:183], v[72:75]
    buffer_load_dwordx4 v[212:215], v52, s[24:27], s39 offen offset:2048 sc1
    v_mfma_f32_16x16x32_bf16 v[76:79], a[40:43], v[180:183], v[76:79]
    v_mfma_f32_16x16x32_bf16 v[80:83], a[44:47], v[180:183], v[80:83]
    s_waitcnt vmcnt(7)
    v_mfma_f32_16x16x32_bf16 v[68:71], a[48:51], v[184:187], v[68:71]
    v_mfma_f32_16x16x32_bf16 v[72:75], a[52:55], v[184:187], v[72:75]
    buffer_load_dwordx4 v[216:219], v52, s[24:27], s39 offen offset:3072 sc1
    v_mfma_f32_16x16x32_bf16 v[76:79], a[56:59], v[184:187], v[76:79]
    v_mfma_f32_16x16x32_bf16 v[80:83], a[60:63], v[184:187], v[80:83]
    s_waitcnt vmcnt(7)
    s_barrier
    v_mfma_f32_16x16x32_bf16 v[68:71], a[64:67], v[188:191], v[68:71]
    ds_read_b64_tr_b16 a[0:1], v44 offset:0
    ds_read_b64_tr_b16 a[2:3], v44 offset:8192
    v_mfma_f32_16x16x32_bf16 v[72:75], a[68:71], v[188:191], v[72:75]
    buffer_load_dwordx4 v[220:223], v52, s[24:27], s52 offen offset:0 sc1
    v_mfma_f32_16x16x32_bf16 v[76:79], a[72:75], v[188:191], v[76:79]
    ds_read_b64_tr_b16 a[4:5], v45 offset:0
    ds_read_b64_tr_b16 a[6:7], v45 offset:8192
    v_mfma_f32_16x16x32_bf16 v[80:83], a[76:79], v[188:191], v[80:83]
    ds_read_b64_tr_b16 a[8:9], v46 offset:0
    s_waitcnt vmcnt(7)
    v_mfma_f32_16x16x32_bf16 v[68:71], a[80:83], v[192:195], v[68:71]
    ds_read_b64_tr_b16 a[10:11], v46 offset:8192
    ds_read_b64_tr_b16 a[12:13], v47 offset:0
    v_mfma_f32_16x16x32_bf16 v[72:75], a[84:87], v[192:195], v[72:75]
    buffer_load_dwordx4 v[224:227], v52, s[24:27], s52 offen offset:1024 sc1
    v_mfma_f32_16x16x32_bf16 v[76:79], a[88:91], v[192:195], v[76:79]
    ds_read_b64_tr_b16 a[14:15], v47 offset:8192
    ds_read_b64_tr_b16 a[16:17], v44 offset:16384
    v_mfma_f32_16x16x32_bf16 v[80:83], a[92:95], v[192:195], v[80:83]
    ds_read_b64_tr_b16 a[18:19], v44 offset:24576
    s_waitcnt vmcnt(7)
    v_mfma_f32_16x16x32_bf16 v[68:71], a[96:99], v[196:199], v[68:71]
    ds_read_b64_tr_b16 a[20:21], v45 offset:16384
    ds_read_b64_tr_b16 a[22:23], v45 offset:24576
    v_mfma_f32_16x16x32_bf16 v[72:75], a[100:103], v[196:199], v[72:75]
    buffer_load_dwordx4 v[228:231], v52, s[24:27], s52 offen offset:2048 sc1
    v_mfma_f32_16x16x32_bf16 v[76:79], a[104:107], v[196:199], v[76:79]
    ds_read_b64_tr_b16 a[24:25], v46 offset:16384
    ds_read_b64_tr_b16 a[26:27], v46 offset:24576
    v_mfma_f32_16x16x32_bf16 v[80:83], a[108:111], v[196:199], v[80:83]
    ds_read_b64_tr_b16 a[28:29], v47 offset:16384
    s_waitcnt vmcnt(7)
    v_mfma_f32_16x16x32_bf16 v[68:71], a[112:115], v[200:203], v[68:71]
    ds_read_b64_tr_b16 a[30:31], v47 offset:24576
    ds_read_b64_tr_b16 a[32:33], v44 offset:2048
    v_mfma_f32_16x16x32_bf16 v[72:75], a[116:119], v[200:203], v[72:75]
    buffer_load_dwordx4 v[232:235], v52, s[24:27], s52 offen offset:3072 sc1
    v_mfma_f32_16x16x32_bf16 v[76:79], a[120:123], v[200:203], v[76:79]
    ds_read_b64_tr_b16 a[34:35], v44 offset:10240
    ds_read_b64_tr_b16 a[36:37], v45 offset:2048
    v_mfma_f32_16x16x32_bf16 v[80:83], a[124:127], v[200:203], v[80:83]
    ds_read_b64_tr_b16 a[38:39], v45 offset:10240
    s_waitcnt vmcnt(7)
    v_mfma_f32_16x16x32_bf16 v[68:71], a[128:131], v[204:207], v[68:71]
    ds_read_b64_tr_b16 a[40:41], v46 offset:2048
    ds_read_b64_tr_b16 a[42:43], v46 offset:10240
    v_mfma_f32_16x16x32_bf16 v[72:75], a[132:135], v[204:207], v[72:75]
    buffer_load_dwordx4 v[172:175], v52, s[24:27], s53 offen offset:0 sc1
    v_mfma_f32_16x16x32_bf16 v[76:79], a[136:139], v[204:207], v[76:79]
    ds_read_b64_tr_b16 a[44:45], v47 offset:2048
    ds_read_b64_tr_b16 a[46:47], v47 offset:10240
    v_mfma_f32_16x16x32_bf16 v[80:83], a[140:143], v[204:207], v[80:83]
    ds_read_b64_tr_b16 a[48:49], v44 offset:18432
    s_waitcnt vmcnt(7)
    v_mfma_f32_16x16x32_bf16 v[68:71], a[144:147], v[208:211], v[68:71]
    ds_read_b64_tr_b16 a[50:51], v44 offset:26624
    ds_read_b64_tr_b16 a[52:53], v45 offset:18432
    v_mfma_f32_16x16x32_bf16 v[72:75], a[148:151], v[208:211], v[72:75]
    buffer_load_dwordx4 v[176:179], v52, s[24:27], s53 offen offset:1024 sc1
    v_mfma_f32_16x16x32_bf16 v[76:79], a[152:155], v[208:211], v[76:79]
    ds_read_b64_tr_b16 a[54:55], v45 offset:26624
    ds_read_b64_tr_b16 a[56:57], v46 offset:18432
    v_mfma_f32_16x16x32_bf16 v[80:83], a[156:159], v[208:211], v[80:83]
    ds_read_b64_tr_b16 a[58:59], v46 offset:26624
    s_waitcnt vmcnt(7)
    v_mfma_f32_16x16x32_bf16 v[68:71], a[160:163], v[212:215], v[68:71]
    ds_read_b64_tr_b16 a[60:61], v47 offset:18432
    ds_read_b64_tr_b16 a[62:63], v47 offset:26624
    v_mfma_f32_16x16x32_bf16 v[72:75], a[164:167], v[212:215], v[72:75]
    buffer_load_dwordx4 v[180:183], v52, s[24:27], s53 offen offset:2048 sc1
    v_mfma_f32_16x16x32_bf16 v[76:79], a[168:171], v[212:215], v[76:79]
    ds_read_b64_tr_b16 a[64:65], v44 offset:4096
    ds_read_b64_tr_b16 a[66:67], v44 offset:12288
    v_mfma_f32_16x16x32_bf16 v[80:83], a[172:175], v[212:215], v[80:83]
    ds_read_b64_tr_b16 a[68:69], v45 offset:4096
    s_waitcnt vmcnt(7)
    v_mfma_f32_16x16x32_bf16 v[68:71], a[176:179], v[216:219], v[68:71]
    ds_read_b64_tr_b16 a[70:71], v45 offset:12288
    ds_read_b64_tr_b16 a[72:73], v46 offset:4096
    v_mfma_f32_16x16x32_bf16 v[72:75], a[180:183], v[216:219], v[72:75]
    buffer_load_dwordx4 v[184:187], v52, s[24:27], s53 offen offset:3072 sc1
    v_mfma_f32_16x16x32_bf16 v[76:79], a[184:187], v[216:219], v[76:79]
    ds_read_b64_tr_b16 a[74:75], v46 offset:12288
    ds_read_b64_tr_b16 a[76:77], v47 offset:4096
    v_mfma_f32_16x16x32_bf16 v[80:83], a[188:191], v[216:219], v[80:83]
    ds_read_b64_tr_b16 a[78:79], v47 offset:12288
    s_waitcnt vmcnt(7)
    v_mfma_f32_16x16x32_bf16 v[68:71], a[192:195], v[220:223], v[68:71]
    ds_read_b64_tr_b16 a[80:81], v44 offset:20480
    ds_read_b64_tr_b16 a[82:83], v44 offset:28672
    v_mfma_f32_16x16x32_bf16 v[72:75], a[196:199], v[220:223], v[72:75]
    buffer_load_dwordx4 v[188:191], v52, s[24:27], s54 offen offset:0 sc1
    v_mfma_f32_16x16x32_bf16 v[76:79], a[200:203], v[220:223], v[76:79]
    ds_read_b64_tr_b16 a[84:85], v45 offset:20480
    ds_read_b64_tr_b16 a[86:87], v45 offset:28672
    v_mfma_f32_16x16x32_bf16 v[80:83], a[204:207], v[220:223], v[80:83]
    ds_read_b64_tr_b16 a[88:89], v46 offset:20480
    s_waitcnt vmcnt(7)
    v_mfma_f32_16x16x32_bf16 v[68:71], a[208:211], v[224:227], v[68:71]
    ds_read_b64_tr_b16 a[90:91], v46 offset:28672
    ds_read_b64_tr_b16 a[92:93], v47 offset:20480
    v_mfma_f32_16x16x32_bf16 v[72:75], a[212:215], v[224:227], v[72:75]
    buffer_load_dwordx4 v[192:195], v52, s[24:27], s54 offen offset:1024 sc1
    v_mfma_f32_16x16x32_bf16 v[76:79], a[216:219], v[224:227], v[76:79]
    ds_read_b64_tr_b16 a[94:95], v47 offset:28672
    ds_read_b64_tr_b16 a[96:97], v44 offset:6144
    v_mfma_f32_16x16x32_bf16 v[80:83], a[220:223], v[224:227], v[80:83]
    ds_read_b64_tr_b16 a[98:99], v44 offset:14336
    s_waitcnt vmcnt(7)
    v_mfma_f32_16x16x32_bf16 v[68:71], a[224:227], v[228:231], v[68:71]
    ds_read_b64_tr_b16 a[100:101], v45 offset:6144
    ds_read_b64_tr_b16 a[102:103], v45 offset:14336
    v_mfma_f32_16x16x32_bf16 v[72:75], a[228:231], v[228:231], v[72:75]
    buffer_load_dwordx4 v[196:199], v52, s[24:27], s54 offen offset:2048 sc1
    v_mfma_f32_16x16x32_bf16 v[76:79], a[232:235], v[228:231], v[76:79]
    ds_read_b64_tr_b16 a[104:105], v46 offset:6144
    ds_read_b64_tr_b16 a[106:107], v46 offset:14336
    v_mfma_f32_16x16x32_bf16 v[80:83], a[236:239], v[228:231], v[80:83]
    ds_read_b64_tr_b16 a[108:109], v47 offset:6144
    s_waitcnt vmcnt(7)
    v_mfma_f32_16x16x32_bf16 v[68:71], a[240:243], v[232:235], v[68:71]
    ds_read_b64_tr_b16 a[110:111], v47 offset:14336
    ds_read_b64_tr_b16 a[112:113], v44 offset:22528
    v_mfma_f32_16x16x32_bf16 v[72:75], a[244:247], v[232:235], v[72:75]
    buffer_load_dwordx4 v[200:203], v52, s[24:27], s54 offen offset:3072 sc1
    v_mfma_f32_16x16x32_bf16 v[76:79], a[248:251], v[232:235], v[76:79]
    ds_read_b64_tr_b16 a[114:115], v44 offset:30720
    ds_read_b64_tr_b16 a[116:117], v45 offset:22528
    v_mfma_f32_16x16x32_bf16 v[80:83], a[252:255], v[232:235], v[80:83]
    ds_read_b64_tr_b16 a[118:119], v45 offset:30720
    s_waitcnt vmcnt(7)
    v_mfma_f32_16x16x32_bf16 v[68:71], a[0:3], v[172:175], v[68:71]
    ds_read_b64_tr_b16 a[120:121], v46 offset:22528
    ds_read_b64_tr_b16 a[122:123], v46 offset:30720
    v_mfma_f32_16x16x32_bf16 v[72:75], a[4:7], v[172:175], v[72:75]
    buffer_load_dwordx4 v[204:207], v52, s[24:27], s55 offen offset:0 sc1
    v_mfma_f32_16x16x32_bf16 v[76:79], a[8:11], v[172:175], v[76:79]
    ds_read_b64_tr_b16 a[124:125], v47 offset:22528
    ds_read_b64_tr_b16 a[126:127], v47 offset:30720
    v_mfma_f32_16x16x32_bf16 v[80:83], a[12:15], v[172:175], v[80:83]
    ds_read_b64_tr_b16 a[128:129], v44 offset:32768
    s_waitcnt vmcnt(7)
    v_mfma_f32_16x16x32_bf16 v[68:71], a[16:19], v[176:179], v[68:71]
    ds_read_b64_tr_b16 a[130:131], v44 offset:40960
    ds_read_b64_tr_b16 a[132:133], v45 offset:32768
    v_mfma_f32_16x16x32_bf16 v[72:75], a[20:23], v[176:179], v[72:75]
    buffer_load_dwordx4 v[208:211], v52, s[24:27], s55 offen offset:1024 sc1
    v_mfma_f32_16x16x32_bf16 v[76:79], a[24:27], v[176:179], v[76:79]
    ds_read_b64_tr_b16 a[134:135], v45 offset:40960
    ds_read_b64_tr_b16 a[136:137], v46 offset:32768
    v_mfma_f32_16x16x32_bf16 v[80:83], a[28:31], v[176:179], v[80:83]
    ds_read_b64_tr_b16 a[138:139], v46 offset:40960
    s_waitcnt vmcnt(7)
    v_mfma_f32_16x16x32_bf16 v[68:71], a[32:35], v[180:183], v[68:71]
    ds_read_b64_tr_b16 a[140:141], v47 offset:32768
    ds_read_b64_tr_b16 a[142:143], v47 offset:40960
    v_mfma_f32_16x16x32_bf16 v[72:75], a[36:39], v[180:183], v[72:75]
    buffer_load_dwordx4 v[212:215], v52, s[24:27], s55 offen offset:2048 sc1
    v_mfma_f32_16x16x32_bf16 v[76:79], a[40:43], v[180:183], v[76:79]
    ds_read_b64_tr_b16 a[144:145], v44 offset:49152
    ds_read_b64_tr_b16 a[146:147], v44 offset:57344
    v_mfma_f32_16x16x32_bf16 v[80:83], a[44:47], v[180:183], v[80:83]
    ds_read_b64_tr_b16 a[148:149], v45 offset:49152
    s_waitcnt vmcnt(7)
    v_mfma_f32_16x16x32_bf16 v[68:71], a[48:51], v[184:187], v[68:71]
    ds_read_b64_tr_b16 a[150:151], v45 offset:57344
    ds_read_b64_tr_b16 a[152:153], v46 offset:49152
    v_mfma_f32_16x16x32_bf16 v[72:75], a[52:55], v[184:187], v[72:75]
    buffer_load_dwordx4 v[216:219], v52, s[24:27], s55 offen offset:3072 sc1
    v_mfma_f32_16x16x32_bf16 v[76:79], a[56:59], v[184:187], v[76:79]
    ds_read_b64_tr_b16 a[154:155], v46 offset:57344
    ds_read_b64_tr_b16 a[156:157], v47 offset:49152
    v_mfma_f32_16x16x32_bf16 v[80:83], a[60:63], v[184:187], v[80:83]
    ds_read_b64_tr_b16 a[158:159], v47 offset:57344
    s_waitcnt vmcnt(7)
    v_mfma_f32_16x16x32_bf16 v[68:71], a[64:67], v[188:191], v[68:71]
    ds_read_b64_tr_b16 a[160:161], v44 offset:34816
    ds_read_b64_tr_b16 a[162:163], v44 offset:43008
    v_mfma_f32_16x16x32_bf16 v[72:75], a[68:71], v[188:191], v[72:75]
    buffer_load_dwordx4 v[220:223], v52, s[24:27], s101 offen offset:0 sc1
    v_mfma_f32_16x16x32_bf16 v[76:79], a[72:75], v[188:191], v[76:79]
    ds_read_b64_tr_b16 a[164:165], v45 offset:34816
    ds_read_b64_tr_b16 a[166:167], v45 offset:43008
    v_mfma_f32_16x16x32_bf16 v[80:83], a[76:79], v[188:191], v[80:83]
    ds_read_b64_tr_b16 a[168:169], v46 offset:34816
    s_waitcnt vmcnt(7)
    v_mfma_f32_16x16x32_bf16 v[68:71], a[80:83], v[192:195], v[68:71]
    ds_read_b64_tr_b16 a[170:171], v46 offset:43008
    ds_read_b64_tr_b16 a[172:173], v47 offset:34816
    v_mfma_f32_16x16x32_bf16 v[72:75], a[84:87], v[192:195], v[72:75]
    buffer_load_dwordx4 v[224:227], v52, s[24:27], s101 offen offset:1024 sc1
    v_mfma_f32_16x16x32_bf16 v[76:79], a[88:91], v[192:195], v[76:79]
    ds_read_b64_tr_b16 a[174:175], v47 offset:43008
    ds_read_b64_tr_b16 a[176:177], v44 offset:51200
    v_mfma_f32_16x16x32_bf16 v[80:83], a[92:95], v[192:195], v[80:83]
    ds_read_b64_tr_b16 a[178:179], v44 offset:59392
    s_waitcnt vmcnt(7)
    v_mfma_f32_16x16x32_bf16 v[68:71], a[96:99], v[196:199], v[68:71]
    ds_read_b64_tr_b16 a[180:181], v45 offset:51200
    ds_read_b64_tr_b16 a[182:183], v45 offset:59392
    v_mfma_f32_16x16x32_bf16 v[72:75], a[100:103], v[196:199], v[72:75]
    buffer_load_dwordx4 v[228:231], v52, s[24:27], s101 offen offset:2048 sc1
    v_mfma_f32_16x16x32_bf16 v[76:79], a[104:107], v[196:199], v[76:79]
    ds_read_b64_tr_b16 a[184:185], v46 offset:51200
    ds_read_b64_tr_b16 a[186:187], v46 offset:59392
    v_mfma_f32_16x16x32_bf16 v[80:83], a[108:111], v[196:199], v[80:83]
    ds_read_b64_tr_b16 a[188:189], v47 offset:51200
    s_waitcnt vmcnt(7)
    v_mfma_f32_16x16x32_bf16 v[68:71], a[112:115], v[200:203], v[68:71]
    ds_read_b64_tr_b16 a[190:191], v47 offset:59392
    ds_read_b64_tr_b16 a[192:193], v44 offset:36864
    v_mfma_f32_16x16x32_bf16 v[72:75], a[116:119], v[200:203], v[72:75]
    buffer_load_dwordx4 v[232:235], v52, s[24:27], s101 offen offset:3072 sc1
    v_mfma_f32_16x16x32_bf16 v[76:79], a[120:123], v[200:203], v[76:79]
    ds_read_b64_tr_b16 a[194:195], v44 offset:45056
    ds_read_b64_tr_b16 a[196:197], v45 offset:36864
    v_mfma_f32_16x16x32_bf16 v[80:83], a[124:127], v[200:203], v[80:83]
    ds_read_b64_tr_b16 a[198:199], v45 offset:45056
    s_waitcnt vmcnt(7)
    v_mfma_f32_16x16x32_bf16 v[68:71], a[128:131], v[204:207], v[68:71]
    ds_read_b64_tr_b16 a[200:201], v46 offset:36864
    ds_read_b64_tr_b16 a[202:203], v46 offset:45056
    v_mfma_f32_16x16x32_bf16 v[72:75], a[132:135], v[204:207], v[72:75]
    v_mfma_f32_16x16x32_bf16 v[76:79], a[136:139], v[204:207], v[76:79]
    ds_read_b64_tr_b16 a[204:205], v47 offset:36864
    ds_read_b64_tr_b16 a[206:207], v47 offset:45056
    v_mfma_f32_16x16x32_bf16 v[80:83], a[140:143], v[204:207], v[80:83]
    ds_read_b64_tr_b16 a[208:209], v44 offset:53248
    s_waitcnt vmcnt(6)
    v_mfma_f32_16x16x32_bf16 v[68:71], a[144:147], v[208:211], v[68:71]
    ds_read_b64_tr_b16 a[210:211], v44 offset:61440
    ds_read_b64_tr_b16 a[212:213], v45 offset:53248
    v_mfma_f32_16x16x32_bf16 v[72:75], a[148:151], v[208:211], v[72:75]
    v_mfma_f32_16x16x32_bf16 v[76:79], a[152:155], v[208:211], v[76:79]
    ds_read_b64_tr_b16 a[214:215], v45 offset:61440
    ds_read_b64_tr_b16 a[216:217], v46 offset:53248
    v_mfma_f32_16x16x32_bf16 v[80:83], a[156:159], v[208:211], v[80:83]
    ds_read_b64_tr_b16 a[218:219], v46 offset:61440
    s_waitcnt vmcnt(5)
    v_mfma_f32_16x16x32_bf16 v[68:71], a[160:163], v[212:215], v[68:71]
    ds_read_b64_tr_b16 a[220:221], v47 offset:53248
    ds_read_b64_tr_b16 a[222:223], v47 offset:61440
    v_mfma_f32_16x16x32_bf16 v[72:75], a[164:167], v[212:215], v[72:75]
    v_mfma_f32_16x16x32_bf16 v[76:79], a[168:171], v[212:215], v[76:79]
    ds_read_b64_tr_b16 a[224:225], v44 offset:38912
    ds_read_b64_tr_b16 a[226:227], v44 offset:47104
    v_mfma_f32_16x16x32_bf16 v[80:83], a[172:175], v[212:215], v[80:83]
    ds_read_b64_tr_b16 a[228:229], v45 offset:38912
    s_waitcnt vmcnt(4)
    v_mfma_f32_16x16x32_bf16 v[68:71], a[176:179], v[216:219], v[68:71]
    ds_read_b64_tr_b16 a[230:231], v45 offset:47104
    ds_read_b64_tr_b16 a[232:233], v46 offset:38912
    v_mfma_f32_16x16x32_bf16 v[72:75], a[180:183], v[216:219], v[72:75]
    v_mfma_f32_16x16x32_bf16 v[76:79], a[184:187], v[216:219], v[76:79]
    ds_read_b64_tr_b16 a[234:235], v46 offset:47104
    ds_read_b64_tr_b16 a[236:237], v47 offset:38912
    v_mfma_f32_16x16x32_bf16 v[80:83], a[188:191], v[216:219], v[80:83]
    ds_read_b64_tr_b16 a[238:239], v47 offset:47104
    s_waitcnt vmcnt(3)
    v_mfma_f32_16x16x32_bf16 v[68:71], a[192:195], v[220:223], v[68:71]
    ds_read_b64_tr_b16 a[240:241], v44 offset:55296
    ds_read_b64_tr_b16 a[242:243], v44 offset:63488
    v_mfma_f32_16x16x32_bf16 v[72:75], a[196:199], v[220:223], v[72:75]
    v_mfma_f32_16x16x32_bf16 v[76:79], a[200:203], v[220:223], v[76:79]
    ds_read_b64_tr_b16 a[244:245], v45 offset:55296
    ds_read_b64_tr_b16 a[246:247], v45 offset:63488
    v_mfma_f32_16x16x32_bf16 v[80:83], a[204:207], v[220:223], v[80:83]
    ds_read_b64_tr_b16 a[248:249], v46 offset:55296
    s_waitcnt vmcnt(2) lgkmcnt(13)
    v_mfma_f32_16x16x32_bf16 v[68:71], a[208:211], v[224:227], v[68:71]
    ds_read_b64_tr_b16 a[250:251], v46 offset:63488
    ds_read_b64_tr_b16 a[252:253], v47 offset:55296
    v_mfma_f32_16x16x32_bf16 v[72:75], a[212:215], v[224:227], v[72:75]
    v_mfma_f32_16x16x32_bf16 v[76:79], a[216:219], v[224:227], v[76:79]
    ds_read_b64_tr_b16 a[254:255], v47 offset:63488
    v_mfma_f32_16x16x32_bf16 v[80:83], a[220:223], v[224:227], v[80:83]
    s_waitcnt vmcnt(1) lgkmcnt(8)
    v_mfma_f32_16x16x32_bf16 v[68:71], a[224:227], v[228:231], v[68:71]
    v_mfma_f32_16x16x32_bf16 v[72:75], a[228:231], v[228:231], v[72:75]
    v_mfma_f32_16x16x32_bf16 v[76:79], a[232:235], v[228:231], v[76:79]
    v_mfma_f32_16x16x32_bf16 v[80:83], a[236:239], v[228:231], v[80:83]
    s_waitcnt vmcnt(0) lgkmcnt(0)
    v_mfma_f32_16x16x32_bf16 v[68:71], a[240:243], v[232:235], v[68:71]
    v_mfma_f32_16x16x32_bf16 v[72:75], a[244:247], v[232:235], v[72:75]
    v_mfma_f32_16x16x32_bf16 v[76:79], a[248:251], v[232:235], v[76:79]
    v_mfma_f32_16x16x32_bf16 v[80:83], a[252:255], v[232:235], v[80:83]
    s_nop 0
    s_nop 4
    v_pk_fma_f32 v[68:69], v[68:69], v[84:85], v[100:101]
    v_pk_fma_f32 v[70:71], v[70:71], v[86:87], v[102:103]
    v_cvt_pk_bf16_f32 v164, v68, v69
    v_cvt_pk_bf16_f32 v165, v70, v71
    ds_write_b64 v48, v[164:165]
    v_pk_fma_f32 v[72:73], v[72:73], v[88:89], v[104:105]
    v_pk_fma_f32 v[74:75], v[74:75], v[90:91], v[106:107]
    v_cvt_pk_bf16_f32 v166, v72, v73
    v_cvt_pk_bf16_f32 v167, v74, v75
    ds_write_b64 v49, v[166:167]
    v_pk_fma_f32 v[76:77], v[76:77], v[92:93], v[108:109]
    v_pk_fma_f32 v[78:79], v[78:79], v[94:95], v[110:111]
    v_cvt_pk_bf16_f32 v168, v76, v77
    v_cvt_pk_bf16_f32 v169, v78, v79
    ds_write_b64 v50, v[168:169]
    v_pk_fma_f32 v[80:81], v[80:81], v[96:97], v[112:113]
    v_pk_fma_f32 v[82:83], v[82:83], v[98:99], v[114:115]
    v_cvt_pk_bf16_f32 v170, v80, v81
    v_cvt_pk_bf16_f32 v171, v82, v83
    ds_write_b64 v51, v[170:171]
    s_waitcnt lgkmcnt(0)
    ds_read_b128 v[172:175], v60
    ds_read_b128 v[176:179], v60 offset:1024
    s_waitcnt lgkmcnt(1)
    buffer_store_dwordx4 v[172:175], v10, s[28:31], s42 offen sc1
    s_waitcnt lgkmcnt(0)
    buffer_store_dwordx4 v[176:179], v11, s[28:31], s37 offen sc1
L_end:
    s_endpgm
L_code_end:
.section .rodata,"a"
.p2align 6
.amdhsa_kernel standalone__dcn_v2_cross__recsys_kernel
  .amdhsa_next_free_vgpr 492
  .amdhsa_next_free_sgpr 102
  .amdhsa_accum_offset 236
  .amdhsa_group_segment_fixed_size 0
  .amdhsa_kernarg_size 48
  .amdhsa_user_sgpr_count 2
  .amdhsa_user_sgpr_kernarg_segment_ptr 1
  .amdhsa_system_sgpr_workgroup_id_x 1
  .amdhsa_float_denorm_mode_32 3
.end_amdhsa_kernel
```
